```python
import torch

def _softmax(x, axis=-1):
    return torch.softmax(x, dim=axis)
def _gelu(x):
    return torch.nn.functional.gelu(x, approximate="tanh")
def _silu(x):
    return torch.nn.functional.silu(x)
def _sigmoid(x):
    return torch.sigmoid(x)
def _layernorm(x, axis=-1, eps=1e-5):
    m = x.mean(dim=axis, keepdim=True)
    v = x.var(dim=axis, keepdim=True, unbiased=False)
    return (x - m) / torch.sqrt(v + eps)
def _scatter_add(tgt, idx, src, axis=0):
    return tgt.clone().index_add_(axis, idx, src)
def _segment_sum(src, seg, n):
    out = torch.zeros((n,) + src.shape[1:], dtype=src.dtype)
    return out.index_add_(0, seg, src)
def _pad(x, pw):
    flat = tuple(v for pair in reversed(pw) for v in pair)
    return torch.nn.functional.pad(x, flat)

kernel_name = 'parallel_sum__sliding_block__dense_activation_gelu__prompt'

def setup_inputs():

    _w = (lambda a: (lambda t: t.to(torch.bfloat16) if t.is_floating_point() else t)(torch.as_tensor(a)))
    def _A_setup():
        B, S, D = 1, 2048, 512
        return {
            "x": _w((lambda *s: torch.randn(*s, dtype=torch.bfloat16) * 0.05)(B, S, D)),
            "wqkv": _w((lambda *s: torch.randn(*s, dtype=torch.bfloat16) * 0.05)(D, 3 * D)),
            "wo": _w((lambda *s: torch.randn(*s, dtype=torch.bfloat16) * 0.05)(D, D)),
        }
    _A_in = _A_setup()

    def _B_setup():
        B, S, D, F = 1, 2048, 512, 1792
        return {
            "x": _w((lambda *s: torch.randn(*s, dtype=torch.bfloat16) * 0.05)(B, S, D)),
            "w1": _w((lambda *s: torch.randn(*s, dtype=torch.bfloat16) * 0.8)(D, F) * (D ** -0.5)),
            "b1": _w((lambda *s: torch.randn(*s, dtype=torch.bfloat16) * 0.8)(F) * 0.01),
            "w2": _w((lambda *s: torch.randn(*s, dtype=torch.bfloat16) * 0.8)(F, D) * (F ** -0.5)),
            "b2": _w((lambda *s: torch.randn(*s, dtype=torch.bfloat16) * 0.8)(D) * 0.01),
        }
    _B_in = _B_setup()

    return {
        "A_x": _A_in["x"],
        "A_wqkv": _A_in["wqkv"],
        "A_wo": _A_in["wo"],
        "B_x": _B_in["x"],
        "B_w1": _B_in["w1"],
        "B_b1": _B_in["b1"],
        "B_w2": _B_in["w2"],
        "B_b2": _B_in["b2"],
    }

def reference(A_x, A_wqkv, A_wo, B_x, B_w1, B_b1, B_w2, B_b2):
    def _A_ref(x, wqkv, wo):
        B, S, D = x.shape
        H = 32; Dh = D // H; W = 256
        qkv = (lambda x, *d: x.permute(*d))((x @ wqkv).reshape(B, S, 3, H, Dh), 2, 0, 3, 1, 4)
        q, k, v = qkv[0], qkv[1], qkv[2]
        scores = torch.einsum("bhqd,bhkd->bhqk", q, k) * (Dh ** -0.5)
        idx = torch.arange(S)
        mask = (idx[:, None] - idx[None, :] >= 0) & (idx[:, None] - idx[None, :] < W)
        scores = torch.where(mask[None, None], scores, -1e9)
        p = _softmax(scores, axis=-1)
        o = torch.einsum("bhqk,bhkd->bhqd", p, v)
        return (lambda x, *d: x.permute(*d))(o, 0, 2, 1, 3).reshape(B, S, D) @ wo

    def _B_ref(x, w1, b1, w2, b2):
        h = torch.einsum("bsd,df->bsf", x, w1) + b1
        h = _gelu(h)
        return torch.einsum("bsf,fd->bsd", h, w2) + b2

    x = A_x
    xn = _layernorm(x, axis=-1)
    return x + _A_ref(xn, A_wqkv, A_wo) + _B_ref(xn, B_w1, B_b1, B_w2, B_b2)
```

```asm
; @launch grid=(256,1,1) block=(512,1,1) lds=163840
.amdgcn_target "amdgcn-amd-amdhsa--gfx950"
.text
.globl parallel_sum__sliding_block__dense_activation_gelu__prompt_kernel
.p2align 8
.type parallel_sum__sliding_block__dense_activation_gelu__prompt_kernel,@function
parallel_sum__sliding_block__dense_activation_gelu__prompt_kernel:
    s_cmp_ge_u32 s2, 256
    s_cbranch_scc1 L_end
    s_load_dwordx16 s[64:79], s[0:1], 0
    s_load_dwordx4 s[80:83], s[0:1], 64
    s_load_dwordx2 s[84:85], s[0:1], 80
    v_lshrrev_b32 v1, 6, v0
    v_and_b32 v0, 63, v0
    v_readfirstlane_b32 s48, v1
    s_and_b32 s60, s2, 7
    s_lshr_b32 s61, s2, 3
    s_and_b32 s51, s60, 1
    s_and_b32 s86, s61, 7
    s_lshl3_add_u32 s51, s51, s86
    s_lshr_b32 s54, s61, 4
    s_and_b32 s52, s60, 6
    s_bfe_u32 s88, s61, 0x10003
    s_add_u32 s52, s52, s88
    s_lshr_b32 s49, s48, 2
    s_lshl1_add_u32 s50, s49, s48
    s_and_b32 s50, s50, 3
    s_lshl2_add_u32 s53, s51, s50
    s_lshl_b32 s55, s48, 12
    s_and_b32 s86, s60, 1
    s_lshl_b32 s86, s86, 5
    s_add_u32 s86, s86, s61
    s_and_b32 s98, s86, 3
    s_lshr_b32 s86, s86, 2
    s_lshr_b32 s87, s60, 1
    s_lshr_b32 s101, s86, 1
    s_and_b32 s88, s86, 1
    s_lshl3_add_u32 s101, s101, s88
    s_lshl1_add_u32 s101, s87, s101
    s_add_u32 s88, s87, 48
    s_cmp_eq_u32 s86, 12
    s_cselect_b32 s101, s88, s101
    s_cmp_gt_u32 s86, 12
    s_cselect_b32 s101, 52, s101
    s_and_b32 s90, s60, 1
    s_lshl2_add_u32 s90, s90, s87
    s_lshl_b32 s90, s90, 5
    s_add_u32 s90, s90, s61
    s_lshl3_add_u32 s90, s90, s48
    s_movk_i32 s3, 3072
    s_cmp_ge_u32 s101, 24
    s_cselect_b32 s3, 3584, s3
    s_and_b32 s88, s61, 3
    s_lshl2_add_u32 s95, s60, s88
    s_lshr_b32 s96, s61, 2
    s_and_b32 s99, s2, 31
    v_lshrrev_b32 v32, 3, v0
    v_and_b32 v33, 7, v0
    v_lshlrev_b32 v15, 4, v0
    v_mov_b32 v14, 1065369472
    s_lshl_b32 s89, s48, 4
    s_lshl_b32 s88, s51, 7
    s_add_u32 s88, s88, s89
    v_add_u32 v34, s88, v32
    v_lshrrev_b32 v35, 1, v32
    v_xor_b32 v35, v35, v33
    v_lshlrev_b32 v35, 4, v35
    v_lshl_add_u32 v10, v34, 10, v35
    v_xor_b32 v11, 64, v10
    v_add_u32 v11, 7168, v11
    v_and_b32 v35, 2, v32
    v_lshlrev_b32 v35, 1, v35
    v_xor_b32 v35, v35, v33
    v_lshlrev_b32 v35, 4, v35
    v_add_u32 v34, s89, v32
    v_mad_u32_u24 v20, v34, s3, v35
    s_lshl_b32 s89, s48, 3
    v_add_u32 v36, s89, v32
    v_mul_u32_u24 v37, 3072, v36
    v_add_u32 v37, v37, v35
    v_mul_u32_u24 v38, 3584, v36
    v_add_u32 v38, v38, v35
    v_lshl_add_u32 v1, v36, 10, v35
    s_lshl_b32 s88, s96, 7
    s_add_u32 s88, s88, 4096
    v_add_u32 v1, s88, v1
    s_waitcnt lgkmcnt(0)
    s_mov_b32 s8, s64
    s_and_b32 s9, s65, 0xffff
    s_mov_b32 s10, 2097152
    s_mov_b32 s11, 0x20000
    s_sub_u32 s12, s66, 4096
    s_subb_u32 s13, s67, 0
    s_and_b32 s13, s13, 0xffff
    s_mov_b32 s14, 1576960
    s_mov_b32 s15, 0x20000
    s_sub_u32 s16, s72, 4096
    s_subb_u32 s17, s73, 0
    s_and_b32 s17, s17, 0xffff
    s_mov_b32 s18, 1839104
    s_mov_b32 s19, 0x20000
    s_mov_b32 s28, s84
    s_and_b32 s29, s85, 0xffff
    s_mov_b32 s30, 17825792
    s_mov_b32 s31, 0x20000
    s_mov_b32 s32, s80
    s_and_b32 s33, s81, 0xffff
    s_mov_b32 s34, 2097152
    s_mov_b32 s35, 0x20000
    s_mov_b32 s36, s82
    s_and_b32 s37, s83, 0xffff
    s_mov_b32 s38, 256
    s_mov_b32 s39, 0x20000
    s_or_b32 s60, s52, s54
    s_cmp_lg_u32 s60, 0
    s_cbranch_scc1 NORST_1
    s_lshl3_add_u32 s60, s51, s48
    s_lshl_b32 s60, s60, 11
    s_add_u32 s60, s60, 15728640
    v_mov_b32 v40, 0
    v_mov_b32 v41, 0
    v_mov_b32 v42, 0
    v_mov_b32 v43, 0
    buffer_store_dwordx4 v[40:43], v15, s[28:31], s60 offen sc1
    buffer_store_dwordx4 v[40:43], v15, s[28:31], s60 offen offset:1024 sc1
    s_nop 1
NORST_1:
    s_cmp_eq_u32 s54, 1
    s_cbranch_scc1 L_type2
    s_lshl_b32 s58, s52, 7
    s_add_u32 s56, s58, 1024
    s_add_u32 s57, s58, 2048
    s_lshr_b32 s59, s52, 1
    s_add_u32 s59, s59, 24
    s_lshl_b32 s59, s59, 7
    s_add_u32 s88, s56, 2048
    v_add_u32 v12, s88, v37
    v_mov_b32 v13, v12
    s_lshl_b32 s60, s90, 10
    buffer_load_dwordx4 v[240:243], v15, s[8:11], s60 offen
    s_cmp_ge_u32 s101, 24
    s_cselect_b32 s80, s16, s12
    s_cselect_b32 s81, s17, s13
    s_cselect_b32 s82, s18, s14
    s_mov_b32 s83, 0x20000
    s_cselect_b32 s61, 24, 0
    s_sub_u32 s61, s101, s61
    s_lshl_b32 s61, s61, 7
    s_lshl_b32 s60, s98, 7
    s_mul_i32 s60, s60, s3
    s_add_u32 s60, s60, s61
    s_add_u32 s60, s60, 4096
    s_lshl3_add_u32 s61, s3, s60
    s_sub_u32 s61, s61, 1024
    s_lshr_b32 s86, s55, 1
    s_add_u32 m0, s86, 131072
    s_nop 0
    buffer_load_dwordx4 v20, s[80:83], s60 offen lds
    buffer_load_dwordx4 v20, s[80:83], s61 offen offset:1024 lds
    s_lshr_b32 s60, s2, 3
    s_lshr_b32 s61, s2, 6
    s_lshl1_add_u32 s60, s61, s60
    s_and_b32 s60, s60, 7
    s_lshl_b32 s3, s60, 7
    s_add_u32 m0, s55, 0
    s_movk_i32 s62, 0
    buffer_load_dwordx4 v10, s[8:11], s62 offen lds
    buffer_load_dwordx4 v11, s[8:11], s62 offen offset:1024 lds
    s_mov_b32 s63, 0
    buffer_load_dwordx4 v12, s[12:15], s63 offen offset:2048 lds
    buffer_load_dwordx4 v13, s[12:15], s63 offen offset:3072 lds
    v_and_b32 v26, 31, v0
    v_lshrrev_b32 v27, 5, v0
    v_bfe_u32 v34, v26, 1, 3
    v_xor_b32 v34, v34, v27
    v_lshlrev_b32 v34, 4, v34
    v_and_b32 v35, 15, v0
    v_lshl_add_u32 v34, v35, 7, v34
    v_bfe_u32 v35, v0, 4, 1
    v_lshl_add_u32 v34, v35, 12, v34
    s_lshl_b32 s88, s50, 13
    s_lshl_b32 s89, s49, 6
    s_or_b32 s88, s88, s89
    v_xor_b32 v34, s88, v34
    v_bfe_u32 v36, v0, 2, 2
    v_bfe_u32 v33, v0, 1, 1
    v_lshl_add_u32 v32, v35, 1, v33
    v_and_b32 v33, 2, v36
    v_lshlrev_b32 v33, 1, v33
    v_xor_b32 v32, v32, v33
    v_lshlrev_b32 v32, 4, v32
    s_add_u32 m0, s55, 32768
    s_movk_i32 s62, 128
    buffer_load_dwordx4 v10, s[8:11], s62 offen lds
    v_and_b32 v33, 1, v0
    v_lshl_add_u32 v32, v33, 3, v32
    v_lshl_add_u32 v32, v36, 7, v32
    v_lshl_add_u32 v250, v27, 10, v32
    s_lshr_b32 s88, s55, 1
    s_add_u32 s88, s88, 131072
    v_add_u32 v250, s88, v250
    v_xor_b32 v251, 64, v250
    v_lshl_add_u32 v35, v27, 12, v32
    s_lshl_b32 s88, s49, 14
    s_or_b32 s88, s88, s89
    v_xor_b32 v35, s88, v35
    v_xor_b32 v2, 0, v34
    v_xor_b32 v6, 0, v35
    v_add_u32 v80, 0x10000, v2
    v_add_u32 v84, 0x10000, v6
    v_xor_b32 v3, 32, v34
    v_xor_b32 v7, 8192, v35
    v_add_u32 v81, 0x10000, v3
    v_add_u32 v85, 0x10000, v7
    buffer_load_dwordx4 v11, s[8:11], s62 offen offset:1024 lds
    v_xor_b32 v4, 64, v34
    v_xor_b32 v8, 16384, v35
    v_add_u32 v82, 0x10000, v4
    v_add_u32 v86, 0x10000, v8
    v_xor_b32 v5, 96, v34
    v_xor_b32 v9, 24576, v35
    v_add_u32 v83, 0x10000, v5
    v_add_u32 v87, 0x10000, v9
    s_mov_b32 s93, 3184710632
    v_mov_b32 v18, 0
    v_mov_b32 v19, 0
    s_lshl_b32 s88, s49, 10
    v_lshl_add_u32 v30, v26, 5, s88
    s_lshl_b32 s92, s51, 14
    s_lshl_b32 s89, s52, 5
    s_add_u32 s92, s92, s89
    s_add_u32 s92, s92, 15728640
    s_lshr_b32 s61, s90, 7
    s_lshl_b32 s61, s61, 14
    s_and_b32 s60, s90, 127
    s_mov_b32 s63, 196608
    buffer_load_dwordx4 v12, s[12:15], s63 offen offset:2048 lds
    s_lshl3_add_u32 s60, s60, s61
    s_add_u32 s60, s60, 15735808
    v_lshl_add_u32 v252, v0, 26, s60
    s_lshl_b32 s60, s48, 2
    s_add_u32 s60, s60, 147456
    v_lshl_add_u32 v253, v0, 5, s60
    v_lshlrev_b32 v254, 5, v0
    v_add_u32 v254, 147456, v254
    v_and_b32 v248, 15, v0
    v_lshlrev_b32 v248, 2, v248
    s_lshr_b32 s86, s101, 2
    s_lshl_b32 s86, s86, 14
    s_and_b32 s87, s101, 3
    s_lshl_b32 s87, s87, 11
    s_add_u32 s86, s86, s87
    s_lshl3_add_u32 s86, s98, s86
    s_add_u32 s86, s86, 15736832
    s_cmp_ge_u32 s101, 52
    s_cselect_b32 s87, 1, s48
    s_lshl_b32 s87, s87, 26
    buffer_load_dwordx4 v13, s[12:15], s63 offen offset:3072 lds
    s_add_u32 s86, s86, s87
    v_lshl_add_u32 v255, v0, 5, s86
    s_add_u32 m0, s55, 65536
    s_movk_i32 s62, 256
    buffer_load_dwordx4 v10, s[8:11], s62 offen lds
    buffer_load_dwordx4 v11, s[8:11], s62 offen offset:1024 lds
    s_mov_b32 s63, 393216
    buffer_load_dwordx4 v12, s[12:15], s63 offen offset:2048 lds
    buffer_load_dwordx4 v13, s[12:15], s63 offen offset:3072 lds
    s_waitcnt vmcnt(15)
    s_cmp_eq_u32 s49, 1
    s_cbranch_scc1 NOPRIO_2
    s_setprio 1
NOPRIO_2:
    s_waitcnt vmcnt(8)
    s_barrier
    ds_read_b128 v[128:131], v2 offset:0
    ds_read_b64_tr_b16 v[48:49], v6 offset:2048
    ds_read_b64_tr_b16 v[50:51], v6 offset:2560
    ds_read_b64_tr_b16 v[52:53], v6 offset:3072
    ds_read_b64_tr_b16 v[54:55], v6 offset:3584
    ds_read_b128 v[132:135], v3 offset:0
    ds_read_b64_tr_b16 v[56:57], v7 offset:2048
    ds_read_b64_tr_b16 v[58:59], v7 offset:2560
    ds_read_b64_tr_b16 v[60:61], v7 offset:3072
    ds_read_b64_tr_b16 v[62:63], v7 offset:3584
    s_or_b32 s60, s52, s48
    s_cmp_lg_u32 s60, 0
    s_cbranch_scc1 NOARM_3
    s_lshl_b32 s60, s51, 2
    v_lshl_add_u32 v32, v0, 26, s60
    v_mov_b32 v33, 1
    buffer_store_dword v33, v32, s[36:39], 0 offen offset:64 sc1
NOARM_3:
    ds_read_b128 v[136:139], v4 offset:0
    ds_read_b64_tr_b16 v[64:65], v8 offset:2048
    ds_read_b64_tr_b16 v[66:67], v8 offset:2560
    ds_read_b64_tr_b16 v[68:69], v8 offset:3072
    ds_read_b64_tr_b16 v[70:71], v8 offset:3584
    s_waitcnt lgkmcnt(12)
    v_mfma_f32_32x32x16_bf16 v[96:111], v[48:51], v[128:131], 0
    s_waitcnt lgkmcnt(10)
    v_mfma_f32_32x32x16_bf16 v[112:127], v[128:131], v[52:55], 0
    s_add_u32 m0, s55, 98304
    s_movk_i32 s62, 384
    buffer_load_dwordx4 v10, s[8:11], s62 offen lds
    ds_read_b64_tr_b16 v[232:233], v250
    ds_read_b64_tr_b16 v[234:235], v250 offset:512
    ds_read_b64_tr_b16 v[236:237], v251
    ds_read_b64_tr_b16 v[238:239], v251 offset:512
    v_dot2_f32_bf16 v244, v240, v14, 0
    v_dot2_f32_bf16 v245, v240, v240, 0
    v_dot2_f32_bf16 v244, v241, v14, v244
    v_dot2_f32_bf16 v245, v241, v241, v245
    v_dot2_f32_bf16 v244, v242, v14, v244
    v_dot2_f32_bf16 v245, v242, v242, v245
    v_dot2_f32_bf16 v244, v243, v14, v244
    v_dot2_f32_bf16 v245, v243, v243, v245
    s_waitcnt lgkmcnt(3)
    v_dot2_f32_bf16 v228, v232, v14, 0
    s_waitcnt lgkmcnt(1)
    v_dot2_f32_bf16 v229, v236, v14, 0
    v_dot2_f32_bf16 v228, v233, v14, v228
    v_dot2_f32_bf16 v229, v237, v14, v229
    v_dot2_f32_bf16 v228, v234, v14, v228
    s_waitcnt lgkmcnt(0)
    v_dot2_f32_bf16 v229, v238, v14, v229
    v_dot2_f32_bf16 v228, v235, v14, v228
    v_dot2_f32_bf16 v229, v239, v14, v229
    v_add_f32_dpp v244, v244, v244 quad_perm:[1,0,3,2] row_mask:0xf bank_mask:0xf
    v_add_f32_dpp v245, v245, v245 quad_perm:[1,0,3,2] row_mask:0xf bank_mask:0xf
    s_nop 0
    v_permlane32_swap_b32 v228, v229
    v_add_f32 v228, v228, v229
    ds_write_b32 v253, v228
    v_add_f32_dpp v244, v244, v244 quad_perm:[2,3,0,1] row_mask:0xf bank_mask:0xf
    v_add_f32_dpp v245, v245, v245 quad_perm:[2,3,0,1] row_mask:0xf bank_mask:0xf
    ds_read_b128 v[140:143], v5 offset:0
    ds_read_b64_tr_b16 v[72:73], v9 offset:2048
    ds_read_b64_tr_b16 v[74:75], v9 offset:2560
    ds_read_b64_tr_b16 v[76:77], v9 offset:3072
    ds_read_b64_tr_b16 v[78:79], v9 offset:3584
    v_mfma_f32_32x32x16_bf16 v[96:111], v[56:59], v[132:135], v[96:111]
    v_mfma_f32_32x32x16_bf16 v[112:127], v[132:135], v[60:63], v[112:127]
    buffer_load_dwordx4 v11, s[8:11], s62 offen offset:1024 lds
    v_add_f32_dpp v244, v244, v244 row_half_mirror row_mask:0xf bank_mask:0xf
    v_add_f32_dpp v245, v245, v245 row_half_mirror row_mask:0xf bank_mask:0xf
    s_nop 0
    v_add_f32_dpp v244, v244, v244 row_mirror row_mask:0xf bank_mask:0xf
    v_add_f32_dpp v245, v245, v245 row_mirror row_mask:0xf bank_mask:0xf
    v_mov_b32 v246, v244
    v_mov_b32 v247, v245
    s_nop 0
    v_permlane16_swap_b32 v244, v246
    v_permlane16_swap_b32 v245, v247
    v_add_f32 v244, v244, v246
    v_add_f32 v245, v245, v247
    v_mov_b32 v246, v244
    v_mov_b32 v247, v245
    s_nop 0
    v_permlane32_swap_b32 v244, v246
    v_permlane32_swap_b32 v245, v247
    v_add_f32 v244, v244, v246
    v_add_f32 v245, v245, v247
    v_mul_f32 v244, 989855744, v244
    v_mul_f32 v245, 989855744, v245
    v_fma_f32 v245, -v244, v244, v245
    v_max_f32 v245, 0, v245
    v_cvt_pk_bf16_f32 v246, v245, v245
    v_lshlrev_b32 v246, 16, v246
    v_add_f32 v246, 925353388, v246
    v_cvt_pk_bf16_f32 v246, v246, v246
    v_lshlrev_b32 v246, 16, v246
    v_sqrt_f32 v246, v246
    s_nop 0
    v_cvt_pk_bf16_f32 v240, -v244, v246
    v_mov_b32 v241, 1
    s_waitcnt vmcnt(6)
    s_waitcnt lgkmcnt(0)
    s_barrier
    ds_read_b128 v[144:147], v2 offset:32768
    ds_read_b64_tr_b16 v[48:49], v6 offset:34816
    ds_read_b64_tr_b16 v[50:51], v6 offset:35328
    ds_read_b64_tr_b16 v[52:53], v6 offset:35840
    ds_read_b64_tr_b16 v[54:55], v6 offset:36352
    v_mfma_f32_32x32x16_bf16 v[96:111], v[64:67], v[136:139], v[96:111]
    s_mov_b32 s63, 589824
    buffer_load_dwordx4 v12, s[12:15], s63 offen offset:2048 lds
    v_mfma_f32_32x32x16_bf16 v[112:127], v[136:139], v[68:71], v[112:127]
    buffer_load_dwordx4 v13, s[12:15], s63 offen offset:3072 lds
    ds_read_b128 v[232:235], v254
    ds_read_b128 v[236:239], v254 offset:16
    s_waitcnt lgkmcnt(1)
    v_add_f32 v232, v232, v233
    v_add_f32 v234, v234, v235
    s_waitcnt lgkmcnt(0)
    v_add_f32 v236, v236, v237
    v_add_f32 v238, v238, v239
    v_add_f32 v232, v232, v234
    v_add_f32 v236, v236, v238
    v_add_f32 v244, v232, v236
    v_mov_b32 v245, 1
    ds_read_b128 v[148:151], v3 offset:32768
    ds_read_b64_tr_b16 v[56:57], v7 offset:34816
    ds_read_b64_tr_b16 v[58:59], v7 offset:35328
    ds_read_b64_tr_b16 v[60:61], v7 offset:35840
    ds_read_b64_tr_b16 v[62:63], v7 offset:36352
    v_mfma_f32_32x32x16_bf16 v[96:111], v[72:75], v[140:143], v[96:111]
    v_mfma_f32_32x32x16_bf16 v[112:127], v[140:143], v[76:79], v[112:127]
    s_add_u32 m0, s55, 0
    s_movk_i32 s62, 512
    buffer_load_dwordx4 v10, s[8:11], s62 offen lds
    s_sub_u32 s24, s68, 4096
    s_subb_u32 s25, s69, 0
    s_and_b32 s25, s25, 0xffff
    s_mov_b32 s26, 528384
    s_mov_b32 s27, 0x20000
    s_mov_b32 s40, s74
    s_and_b32 s41, s75, 0xffff
    s_mov_b32 s42, 3584
    s_mov_b32 s43, 0x20000
    s_sub_u32 s20, s76, 4096
    s_subb_u32 s21, s77, 0
    s_and_b32 s21, s21, 0xffff
    s_mov_b32 s22, 1839104
    s_mov_b32 s23, 0x20000
    s_mov_b32 s44, s78
    s_and_b32 s45, s79, 0xffff
    s_mov_b32 s46, 1024
    s_mov_b32 s47, 0x20000
    s_lshl_b32 s88, s49, 6
    ds_read_b128 v[152:155], v4 offset:32768
    ds_read_b64_tr_b16 v[64:65], v8 offset:34816
    ds_read_b64_tr_b16 v[66:67], v8 offset:35328
    ds_read_b64_tr_b16 v[68:69], v8 offset:35840
    ds_read_b64_tr_b16 v[70:71], v8 offset:36352
    v_mfma_f32_32x32x16_bf16 v[96:111], v[48:51], v[144:147], v[96:111]
    v_mfma_f32_32x32x16_bf16 v[112:127], v[144:147], v[52:55], v[112:127]
    buffer_load_dwordx4 v11, s[8:11], s62 offen offset:1024 lds
    v_lshl_add_u32 v34, v26, 1, s88
    buffer_load_ushort v28, v34, s[40:43], s58 offen
    s_xor_b32 s97, s49, s52
    s_and_b32 s97, s97, 1
    s_lshl_b32 s97, s97, 6
    v_xor_b32 v34, s97, v34
    buffer_load_ushort v29, v34, s[40:43], s59 offen
    s_lshl1_add_u32 s86, s52, s49
    s_lshl_b32 s86, s86, 17
    s_lshl_b32 s87, s53, 10
    s_add_u32 s86, s86, s87
    s_add_u32 s80, s86, 9437184
    s_mul_i32 s88, s53, 147456
    s_lshl_b32 s87, s49, 11
    s_add_u32 s87, s87, s88
    s_lshl_b32 s89, s58, 5
    s_add_u32 s82, s89, s87
    s_add_u32 s81, s86, 11534336
    s_and_b32 s87, s52, 1
    ds_read_b128 v[156:159], v5 offset:32768
    ds_read_b64_tr_b16 v[72:73], v9 offset:34816
    ds_read_b64_tr_b16 v[74:75], v9 offset:35328
    ds_read_b64_tr_b16 v[76:77], v9 offset:35840
    ds_read_b64_tr_b16 v[78:79], v9 offset:36352
    s_waitcnt lgkmcnt(12)
    v_mfma_f32_32x32x16_bf16 v[96:111], v[56:59], v[148:151], v[96:111]
    s_waitcnt lgkmcnt(10)
    v_mfma_f32_32x32x16_bf16 v[112:127], v[148:151], v[60:63], v[112:127]
    s_mov_b32 s63, 786432
    buffer_load_dwordx4 v12, s[12:15], s63 offen offset:2048 lds
    s_lshl1_add_u32 s87, s87, s49
    s_lshl_b32 s87, s87, 10
    s_add_u32 s87, s87, s88
    s_lshl_b32 s89, s59, 5
    s_add_u32 s83, s89, s87
    s_lshl_b32 s85, s51, 14
    s_lshl_b32 s87, s50, 8
    s_add_u32 s85, s85, s87
    s_add_u32 s85, s85, 15735808
    s_add_u32 s88, s58, 1024
    v_add_u32 v22, s88, v38
    v_lshrrev_b32 v32, 2, v0
    v_mul_u32_u24 v23, 3584, v32
    v_and_b32 v32, 3, v0
    v_lshl_add_u32 v23, v32, 4, v23
    s_and_b32 s88, s52, 1
    s_lshl_b32 s88, s88, 6
    s_add_u32 s88, s88, s59
    s_add_u32 s88, s88, 4096
    s_waitcnt vmcnt(9)
    s_waitcnt lgkmcnt(0)
    s_barrier
    ds_read_b128 v[160:163], v80 offset:0
    ds_read_b64_tr_b16 v[48:49], v84 offset:2048
    ds_read_b64_tr_b16 v[50:51], v84 offset:2560
    ds_read_b64_tr_b16 v[52:53], v84 offset:3072
    ds_read_b64_tr_b16 v[54:55], v84 offset:3584
    v_mfma_f32_32x32x16_bf16 v[96:111], v[64:67], v[152:155], v[96:111]
    buffer_load_dwordx4 v13, s[12:15], s63 offen offset:3072 lds
    v_mfma_f32_32x32x16_bf16 v[112:127], v[152:155], v[68:71], v[112:127]
    s_add_u32 m0, s55, 32768
    s_movk_i32 s62, 640
    buffer_load_dwordx4 v10, s[8:11], s62 offen lds
    v_add_u32 v23, s88, v23
    s_lshl_b32 s78, s48, 7
    s_add_u32 s78, s78, 0
    s_and_b32 s78, s78, 1023
    s_mul_i32 s78, s78, 1792
    s_lshr_b32 s86, s56, 7
    s_add_u32 s86, s86, 0
    s_lshr_b32 s87, s86, 2
    s_lshl_b32 s87, s87, 14
    s_and_b32 s86, s86, 3
    s_lshl_b32 s86, s86, 11
    s_add_u32 s86, s86, s87
    s_add_u32 s56, s86, 15736832
    s_lshr_b32 s86, s57, 7
    s_add_u32 s86, s86, 0
    s_lshr_b32 s87, s86, 2
    s_lshl_b32 s87, s87, 14
    s_and_b32 s86, s86, 3
    s_lshl_b32 s86, s86, 11
    ds_read_b128 v[164:167], v81 offset:0
    ds_read_b64_tr_b16 v[56:57], v85 offset:2048
    ds_read_b64_tr_b16 v[58:59], v85 offset:2560
    ds_read_b64_tr_b16 v[60:61], v85 offset:3072
    ds_read_b64_tr_b16 v[62:63], v85 offset:3584
    v_mfma_f32_32x32x16_bf16 v[96:111], v[72:75], v[156:159], v[96:111]
    v_mfma_f32_32x32x16_bf16 v[112:127], v[156:159], v[76:79], v[112:127]
    buffer_load_dwordx4 v11, s[8:11], s62 offen offset:1024 lds
    s_add_u32 s86, s86, s87
    s_add_u32 s57, s86, 15736832
    s_lshr_b32 s86, s58, 7
    s_add_u32 s86, s86, 24
    s_lshr_b32 s87, s86, 2
    s_lshl_b32 s87, s87, 14
    s_and_b32 s86, s86, 3
    s_lshl_b32 s86, s86, 11
    s_add_u32 s86, s86, s87
    s_add_u32 s58, s86, 15736832
    s_lshr_b32 s86, s59, 7
    s_add_u32 s86, s86, 24
    s_lshr_b32 s87, s86, 2
    s_lshl_b32 s87, s87, 14
    s_and_b32 s86, s86, 3
    s_lshl_b32 s86, s86, 11
    s_add_u32 s86, s86, s87
    s_add_u32 s59, s86, 15736832
    s_lshr_b32 s86, s48, 1
    buffer_load_dword v249, v248, s[36:39], 0 offen offset:64 sc1
    ds_read_b128 v[168:171], v82 offset:0
    ds_read_b64_tr_b16 v[64:65], v86 offset:2048
    ds_read_b64_tr_b16 v[66:67], v86 offset:2560
    ds_read_b64_tr_b16 v[68:69], v86 offset:3072
    ds_read_b64_tr_b16 v[70:71], v86 offset:3584
    s_waitcnt lgkmcnt(12)
    v_mfma_f32_32x32x16_bf16 v[96:111], v[48:51], v[160:163], v[96:111]
    s_waitcnt lgkmcnt(10)
    v_mfma_f32_32x32x16_bf16 v[112:127], v[160:163], v[52:55], v[112:127]
    s_mov_b32 s63, 983040
    buffer_load_dwordx4 v12, s[12:15], s63 offen offset:2048 lds
    s_mov_b32 s98, s56
    s_cmp_eq_u32 s86, 1
    s_cselect_b32 s98, s57, s98
    s_cmp_eq_u32 s86, 2
    s_cselect_b32 s98, s58, s98
    s_cmp_eq_u32 s86, 3
    s_cselect_b32 s98, s59, s98
    s_and_b32 s86, s48, 1
    s_lshl_b32 s86, s86, 10
    s_add_u32 s98, s98, s86
    s_lshr_b32 s65, s2, 5
    s_lshl_b32 s64, s65, 3
    s_sub_u32 s66, s64, 8
    s_add_u32 s64, s64, s48
    s_sub_u32 s75, 8, s64
    s_cmp_gt_u32 s64, 8
    s_cselect_b32 s75, 0, s75
    s_lshl1_add_u32 s66, s48, s66
    s_lshl_b32 s66, s66, 10
    ds_read_b128 v[172:175], v83 offset:0
    ds_read_b64_tr_b16 v[72:73], v87 offset:2048
    ds_read_b64_tr_b16 v[74:75], v87 offset:2560
    ds_read_b64_tr_b16 v[76:77], v87 offset:3072
    ds_read_b64_tr_b16 v[78:79], v87 offset:3584
    s_waitcnt lgkmcnt(12)
    v_mfma_f32_32x32x16_bf16 v[96:111], v[56:59], v[164:167], v[96:111]
    s_waitcnt lgkmcnt(10)
    v_mfma_f32_32x32x16_bf16 v[112:127], v[164:167], v[60:63], v[112:127]
    buffer_load_dwordx4 v13, s[12:15], s63 offen offset:3072 lds
    s_lshl_b32 s61, s99, 16
    s_add_u32 s66, s66, s61
    s_add_u32 s66, s66, 9437184
    s_lshl_b32 s67, s64, 10
    s_add_u32 s67, s67, s61
    s_add_u32 s67, s67, 13631488
    s_lshl1_add_u32 s70, s95, s49
    s_and_b32 s76, s48, 3
    s_mul_i32 s71, s70, 147456
    s_lshl_b32 s61, s76, 12
    s_add_u32 s71, s71, s61
    s_mov_b32 s72, 0
    s_lshl_b32 s77, s65, 15
    s_lshl_b32 s61, s99, 5
    s_add_u32 s77, s77, s61
    s_add_u32 s77, s77, 15729920
    s_mul_i32 s74, s64, 147456
    s_lshl_b32 s61, s99, 10
    s_add_u32 s74, s74, s61
    s_waitcnt vmcnt(11)
    s_waitcnt lgkmcnt(0)
    s_barrier
    ds_read_b128 v[176:179], v80 offset:32768
    ds_read_b64_tr_b16 v[48:49], v84 offset:34816
    ds_read_b64_tr_b16 v[50:51], v84 offset:35328
    ds_read_b64_tr_b16 v[52:53], v84 offset:35840
    ds_read_b64_tr_b16 v[54:55], v84 offset:36352
    v_mfma_f32_32x32x16_bf16 v[96:111], v[64:67], v[168:171], v[96:111]
    v_mfma_f32_32x32x16_bf16 v[112:127], v[168:171], v[68:71], v[112:127]
    s_add_u32 m0, s55, 65536
    s_movk_i32 s62, 768
    buffer_load_dwordx4 v10, s[8:11], s62 offen lds
    s_add_u32 s74, s74, 114688
    s_mov_b32 s40, 0x41065410
    s_mov_b32 s41, 5
    s_and_b32 s61, s95, 3
    s_or_b32 s73, s96, 4
    s_lshl1_add_u32 s73, s61, s73
    s_mul_i32 s61, s73, 52
    s_lshr_b32 s61, s61, 8
    s_mul_i32 s61, s61, 5
    s_sub_u32 s61, s73, s61
    s_add_u32 s73, s96, s95
    s_and_b32 s73, s73, 1
    s_lshl3_add_u32 s73, s73, s61
    ds_read_b128 v[180:183], v81 offset:32768
    ds_read_b64_tr_b16 v[56:57], v85 offset:34816
    ds_read_b64_tr_b16 v[58:59], v85 offset:35328
    ds_read_b64_tr_b16 v[60:61], v85 offset:35840
    ds_read_b64_tr_b16 v[62:63], v85 offset:36352
    v_mfma_f32_32x32x16_bf16 v[96:111], v[72:75], v[172:175], v[96:111]
    v_mfma_f32_32x32x16_bf16 v[112:127], v[172:175], v[76:79], v[112:127]
    buffer_load_dwordx4 v11, s[8:11], s62 offen offset:1024 lds
    s_waitcnt vmcnt(4)
    v_cmp_ne_u32 vcc, 1, v249
    s_nop 0
    s_cmp_eq_u64 vcc, 0
    s_cbranch_scc1 ARMOK_4
    s_mov_b32 s94, 0
ARMLP_5:
    s_nop 4
    s_sleep 2
    buffer_load_dword v249, v248, s[36:39], 0 offen offset:64 sc1
    s_waitcnt vmcnt(0)
    s_add_u32 s94, s94, 1
    s_cmp_gt_u32 s94, 0x40000
    s_cbranch_scc1 ARMOK_4
    v_cmp_ne_u32 vcc, 1, v249
    s_nop 0
    s_cmp_eq_u64 vcc, 0
    s_cbranch_scc0 ARMLP_5
    s_nop 1
ARMOK_4:
    buffer_store_dwordx2 v[240:241], v252, s[28:31], 0 offen sc1
    buffer_store_dwordx2 v[244:245], v255, s[28:31], 0 offen sc1
    ds_read_b128 v[184:187], v82 offset:32768
    ds_read_b64_tr_b16 v[64:65], v86 offset:34816
    ds_read_b64_tr_b16 v[66:67], v86 offset:35328
    ds_read_b64_tr_b16 v[68:69], v86 offset:35840
    ds_read_b64_tr_b16 v[70:71], v86 offset:36352
    s_waitcnt lgkmcnt(12)
    v_mfma_f32_32x32x16_bf16 v[96:111], v[48:51], v[176:179], v[96:111]
    s_waitcnt lgkmcnt(10)
    v_mfma_f32_32x32x16_bf16 v[112:127], v[176:179], v[52:55], v[112:127]
    s_mov_b32 s63, 1179648
    buffer_load_dwordx4 v12, s[12:15], s63 offen offset:2048 lds
    ds_read_b128 v[188:191], v83 offset:32768
    ds_read_b64_tr_b16 v[72:73], v87 offset:34816
    ds_read_b64_tr_b16 v[74:75], v87 offset:35328
    ds_read_b64_tr_b16 v[76:77], v87 offset:35840
    ds_read_b64_tr_b16 v[78:79], v87 offset:36352
    s_waitcnt lgkmcnt(12)
    v_mfma_f32_32x32x16_bf16 v[96:111], v[56:59], v[180:183], v[96:111]
    s_waitcnt lgkmcnt(10)
    v_mfma_f32_32x32x16_bf16 v[112:127], v[180:183], v[60:63], v[112:127]
    buffer_load_dwordx4 v13, s[12:15], s63 offen offset:3072 lds
    s_cmp_gt_u32 s48, 1
    s_cbranch_scc1 NOWARM_6
    s_lshl_b32 s86, s48, 8
    s_add_u32 s86, s86, s2
    s_lshl_b32 s86, s86, 13
    s_add_u32 s86, s86, 4096
    s_sub_u32 s87, s86, 1835008
    s_cmp_lt_u32 s86, 1839104
    s_cselect_b32 s87, 0x40000000, s87
    v_lshlrev_b32 v246, 7, v0
    buffer_load_dword v247, v246, s[20:23], s86 offen
    buffer_load_dword v243, v246, s[24:27], s87 offen
NOWARM_6:
    s_waitcnt lgkmcnt(0)
    s_barrier
    ds_read_b128 v[192:195], v2 offset:0
    ds_read_b64_tr_b16 v[48:49], v6 offset:2048
    ds_read_b64_tr_b16 v[50:51], v6 offset:2560
    ds_read_b64_tr_b16 v[52:53], v6 offset:3072
    ds_read_b64_tr_b16 v[54:55], v6 offset:3584
    v_mfma_f32_32x32x16_bf16 v[96:111], v[64:67], v[184:187], v[96:111]
    v_mfma_f32_32x32x16_bf16 v[112:127], v[184:187], v[68:71], v[112:127]
    s_add_u32 m0, s55, 98304
    s_movk_i32 s62, 896
    buffer_load_dwordx4 v10, s[8:11], s62 offen lds
    ds_read_b128 v[196:199], v3 offset:0
    ds_read_b64_tr_b16 v[56:57], v7 offset:2048
    ds_read_b64_tr_b16 v[58:59], v7 offset:2560
    ds_read_b64_tr_b16 v[60:61], v7 offset:3072
    ds_read_b64_tr_b16 v[62:63], v7 offset:3584
    v_mfma_f32_32x32x16_bf16 v[96:111], v[72:75], v[188:191], v[96:111]
    v_mfma_f32_32x32x16_bf16 v[112:127], v[188:191], v[76:79], v[112:127]
    buffer_load_dwordx4 v11, s[8:11], s62 offen offset:1024 lds
    ds_read_b128 v[200:203], v4 offset:0
    ds_read_b64_tr_b16 v[64:65], v8 offset:2048
    ds_read_b64_tr_b16 v[66:67], v8 offset:2560
    ds_read_b64_tr_b16 v[68:69], v8 offset:3072
    ds_read_b64_tr_b16 v[70:71], v8 offset:3584
    s_waitcnt lgkmcnt(12)
    v_mfma_f32_32x32x16_bf16 v[96:111], v[48:51], v[192:195], v[96:111]
    s_waitcnt lgkmcnt(10)
    v_mfma_f32_32x32x16_bf16 v[112:127], v[192:195], v[52:55], v[112:127]
    s_mov_b32 s63, 1376256
    buffer_load_dwordx4 v12, s[12:15], s63 offen offset:2048 lds
    ds_read_b128 v[204:207], v5 offset:0
    ds_read_b64_tr_b16 v[72:73], v9 offset:2048
    ds_read_b64_tr_b16 v[74:75], v9 offset:2560
    ds_read_b64_tr_b16 v[76:77], v9 offset:3072
    ds_read_b64_tr_b16 v[78:79], v9 offset:3584
    s_waitcnt lgkmcnt(12)
    v_mfma_f32_32x32x16_bf16 v[96:111], v[56:59], v[196:199], v[96:111]
    s_waitcnt lgkmcnt(10)
    v_mfma_f32_32x32x16_bf16 v[112:127], v[196:199], v[60:63], v[112:127]
    buffer_load_dwordx4 v13, s[12:15], s63 offen offset:3072 lds
    s_waitcnt vmcnt(10)
    s_waitcnt lgkmcnt(0)
    s_barrier
    ds_read_b128 v[208:211], v2 offset:32768
    ds_read_b64_tr_b16 v[48:49], v6 offset:34816
    ds_read_b64_tr_b16 v[50:51], v6 offset:35328
    ds_read_b64_tr_b16 v[52:53], v6 offset:35840
    ds_read_b64_tr_b16 v[54:55], v6 offset:36352
    v_mfma_f32_32x32x16_bf16 v[96:111], v[64:67], v[200:203], v[96:111]
    v_mfma_f32_32x32x16_bf16 v[112:127], v[200:203], v[68:71], v[112:127]
    s_add_u32 m0, s55, 0
    s_mov_b32 s63, 3072
    buffer_load_dwordx4 v22, s[16:19], s63 offen offset:0 lds
    ds_read_b128 v[212:215], v3 offset:32768
    ds_read_b64_tr_b16 v[56:57], v7 offset:34816
    ds_read_b64_tr_b16 v[58:59], v7 offset:35328
    ds_read_b64_tr_b16 v[60:61], v7 offset:35840
    ds_read_b64_tr_b16 v[62:63], v7 offset:36352
    v_mfma_f32_32x32x16_bf16 v[96:111], v[72:75], v[204:207], v[96:111]
    v_mfma_f32_32x32x16_bf16 v[112:127], v[204:207], v[76:79], v[112:127]
    s_mov_b32 s63, 231424
    buffer_load_dwordx4 v22, s[16:19], s63 offen offset:1024 lds
    ds_read_b128 v[216:219], v4 offset:32768
    ds_read_b64_tr_b16 v[64:65], v8 offset:34816
    ds_read_b64_tr_b16 v[66:67], v8 offset:35328
    ds_read_b64_tr_b16 v[68:69], v8 offset:35840
    ds_read_b64_tr_b16 v[70:71], v8 offset:36352
    s_waitcnt lgkmcnt(12)
    v_mfma_f32_32x32x16_bf16 v[96:111], v[48:51], v[208:211], v[96:111]
    s_waitcnt lgkmcnt(10)
    v_mfma_f32_32x32x16_bf16 v[112:127], v[208:211], v[52:55], v[112:127]
    s_mov_b32 s63, 459776
    buffer_load_dwordx4 v22, s[16:19], s63 offen offset:2048 lds
    ds_read_b128 v[220:223], v5 offset:32768
    ds_read_b64_tr_b16 v[72:73], v9 offset:34816
    ds_read_b64_tr_b16 v[74:75], v9 offset:35328
    ds_read_b64_tr_b16 v[76:77], v9 offset:35840
    ds_read_b64_tr_b16 v[78:79], v9 offset:36352
    s_waitcnt lgkmcnt(12)
    v_mfma_f32_32x32x16_bf16 v[96:111], v[56:59], v[212:215], v[96:111]
    s_waitcnt lgkmcnt(10)
    v_mfma_f32_32x32x16_bf16 v[112:127], v[212:215], v[60:63], v[112:127]
    s_mov_b32 s63, 688128
    buffer_load_dwordx4 v22, s[16:19], s63 offen offset:3072 lds
    s_lshr_b32 s86, s55, 2
    s_add_u32 m0, s86, 131072
    s_nop 0
    buffer_load_dwordx4 v15, s[28:31], s98 offen sc1 lds
    s_cmp_lg_u32 s48, 0
    s_cbranch_scc1 NOROWG_7
    s_lshl_b32 s86, s51, 14
    s_add_u32 s86, s86, 15735808
    s_mov_b32 m0, 139264
    s_nop 0
    buffer_load_dwordx4 v15, s[28:31], s86 offen sc1 lds
    s_waitcnt vmcnt(63)
NOROWG_7:
    s_waitcnt vmcnt(9)
    s_waitcnt lgkmcnt(0)
    s_barrier
    ds_read_b128 v[224:227], v80 offset:0
    ds_read_b64_tr_b16 v[48:49], v84 offset:2048
    ds_read_b64_tr_b16 v[50:51], v84 offset:2560
    ds_read_b64_tr_b16 v[52:53], v84 offset:3072
    ds_read_b64_tr_b16 v[54:55], v84 offset:3584
    v_mfma_f32_32x32x16_bf16 v[96:111], v[64:67], v[216:219], v[96:111]
    v_mfma_f32_32x32x16_bf16 v[112:127], v[216:219], v[68:71], v[112:127]
    s_add_u32 m0, s55, 32768
    s_mov_b32 s63, 920576
    buffer_load_dwordx4 v22, s[16:19], s63 offen offset:0 lds
    ds_read_b128 v[228:231], v81 offset:0
    ds_read_b64_tr_b16 v[56:57], v85 offset:2048
    ds_read_b64_tr_b16 v[58:59], v85 offset:2560
    ds_read_b64_tr_b16 v[60:61], v85 offset:3072
    ds_read_b64_tr_b16 v[62:63], v85 offset:3584
    v_mfma_f32_32x32x16_bf16 v[96:111], v[72:75], v[220:223], v[96:111]
    v_mfma_f32_32x32x16_bf16 v[112:127], v[220:223], v[76:79], v[112:127]
    s_mov_b32 s63, 1148928
    buffer_load_dwordx4 v22, s[16:19], s63 offen offset:1024 lds
    ds_read_b128 v[232:235], v82 offset:0
    ds_read_b64_tr_b16 v[64:65], v86 offset:2048
    ds_read_b64_tr_b16 v[66:67], v86 offset:2560
    ds_read_b64_tr_b16 v[68:69], v86 offset:3072
    ds_read_b64_tr_b16 v[70:71], v86 offset:3584
    s_waitcnt lgkmcnt(12)
    v_mfma_f32_32x32x16_bf16 v[96:111], v[48:51], v[224:227], v[96:111]
    s_waitcnt lgkmcnt(10)
    v_mfma_f32_32x32x16_bf16 v[112:127], v[224:227], v[52:55], v[112:127]
    s_mov_b32 s63, 1377280
    buffer_load_dwordx4 v22, s[16:19], s63 offen offset:2048 lds
    ds_read_b128 v[236:239], v83 offset:0
    ds_read_b64_tr_b16 v[72:73], v87 offset:2048
    ds_read_b64_tr_b16 v[74:75], v87 offset:2560
    ds_read_b64_tr_b16 v[76:77], v87 offset:3072
    ds_read_b64_tr_b16 v[78:79], v87 offset:3584
    s_waitcnt lgkmcnt(12)
    v_mfma_f32_32x32x16_bf16 v[96:111], v[56:59], v[228:231], v[96:111]
    s_waitcnt lgkmcnt(10)
    v_mfma_f32_32x32x16_bf16 v[112:127], v[228:231], v[60:63], v[112:127]
    s_mov_b32 s63, 1605632
    buffer_load_dwordx4 v22, s[16:19], s63 offen offset:3072 lds
    s_waitcnt vmcnt(4)
    s_waitcnt lgkmcnt(0)
    s_barrier
    ds_read_b128 v[240:243], v80 offset:32768
    ds_read_b64_tr_b16 v[48:49], v84 offset:34816
    ds_read_b64_tr_b16 v[50:51], v84 offset:35328
    ds_read_b64_tr_b16 v[52:53], v84 offset:35840
    ds_read_b64_tr_b16 v[54:55], v84 offset:36352
    v_mfma_f32_32x32x16_bf16 v[96:111], v[64:67], v[232:235], v[96:111]
    v_mfma_f32_32x32x16_bf16 v[112:127], v[232:235], v[68:71], v[112:127]
    s_add_u32 m0, s55, 65536
    s_nop 0
    buffer_load_dwordx4 v23, s[16:19], s78 offen offset:0 lds
    s_lshl_b32 s86, s50, 8
    s_add_u32 s86, s86, 139264
    v_lshl_add_u32 v20, v26, 3, s86
    v_add_u32 v21, 131072, v30
    ds_read_b64 v[16:17], v20
    ds_read_b128 v[32:35], v21
    ds_read_b128 v[36:39], v21 offset:16
    ds_read_b128 v[40:43], v21 offset:2048
    ds_read_b128 v[44:47], v21 offset:2064
    ds_read_b128 v[88:91], v21 offset:4096
    ds_read_b128 v[92:95], v21 offset:4112
    ds_read_b128 v[244:247], v81 offset:32768
    ds_read_b64_tr_b16 v[56:57], v85 offset:34816
    ds_read_b64_tr_b16 v[58:59], v85 offset:35328
    ds_read_b64_tr_b16 v[60:61], v85 offset:35840
    ds_read_b64_tr_b16 v[62:63], v85 offset:36352
    v_mfma_f32_32x32x16_bf16 v[96:111], v[72:75], v[236:239], v[96:111]
    v_mfma_f32_32x32x16_bf16 v[112:127], v[236:239], v[76:79], v[112:127]
    s_add_u32 s78, s78, 56320
    buffer_load_dwordx4 v23, s[16:19], s78 offen offset:1024 lds
    s_waitcnt lgkmcnt(10)
    v_and_b32 v20, v17, v33
    s_waitcnt lgkmcnt(9)
    v_and_b32 v21, v35, v37
    v_and_b32 v20, v20, v39
    s_waitcnt lgkmcnt(8)
    v_and_b32 v21, v21, v41
    v_and_b32 v20, v20, v43
    s_waitcnt lgkmcnt(7)
    v_and_b32 v21, v21, v45
    v_and_b32 v20, v20, v47
    s_waitcnt lgkmcnt(6)
    v_and_b32 v21, v21, v89
    v_and_b32 v20, v20, v91
    s_waitcnt lgkmcnt(5)
    v_and_b32 v21, v21, v93
    v_and_b32 v20, v20, v95
    v_and_b32 v20, v20, v21
    v_cmp_ne_u32 vcc, 1, v20
    s_nop 0
    s_cmp_eq_u64 vcc, 0
    s_cbranch_scc1 GROK_8
    s_mov_b32 s94, 0
GRLP_9:
    s_nop 0
    s_sleep 2
    v_lshlrev_b32 v20, 3, v26
    buffer_load_dwordx2 v[16:17], v20, s[28:31], s85 offen sc1
    buffer_load_dwordx4 v[32:35], v30, s[28:31], s56 offen sc1
    buffer_load_dwordx4 v[36:39], v30, s[28:31], s56 offen offset:16 sc1
    buffer_load_dwordx4 v[40:43], v30, s[28:31], s57 offen sc1
    buffer_load_dwordx4 v[44:47], v30, s[28:31], s57 offen offset:16 sc1
    buffer_load_dwordx4 v[88:91], v30, s[28:31], s58 offen sc1
    buffer_load_dwordx4 v[92:95], v30, s[28:31], s58 offen offset:16 sc1
    s_waitcnt vmcnt(0)
    s_add_u32 s94, s94, 1
    s_cmp_gt_u32 s94, 0x40000
    s_cbranch_scc1 GROK_8
    v_and_b32 v20, v17, v33
    v_and_b32 v21, v35, v37
    v_and_b32 v20, v20, v39
    v_and_b32 v21, v21, v41
    v_and_b32 v20, v20, v43
    v_and_b32 v21, v21, v45
    v_and_b32 v20, v20, v47
    v_and_b32 v21, v21, v89
    v_and_b32 v20, v20, v91
    v_and_b32 v21, v21, v93
    v_and_b32 v20, v20, v95
    v_and_b32 v20, v20, v21
    v_cmp_ne_u32 vcc, 1, v20
    s_nop 0
    s_cmp_eq_u64 vcc, 0
    s_cbranch_scc0 GRLP_9
    s_nop 1
GROK_8:
    v_add_f32 v32, v32, v34
    v_add_f32 v36, v36, v38
    v_add_f32 v40, v40, v42
    v_add_f32 v44, v44, v46
    v_add_f32 v88, v88, v90
    v_add_f32 v92, v92, v94
    v_add_f32 v32, v32, v36
    v_add_f32 v33, v40, v44
    v_add_f32 v34, v88, v92
    v_and_b32 v2, 0xffff0000, v16
    v_rcp_f32 v25, v2
    v_cmp_eq_u32 vcc, 0, v27
    s_nop 1
    v_cndmask_b32 v17, 0, v16, vcc
    v_and_b32 v16, 0xffff, v17
    v_lshl_or_b32 v16, v16, 16, v16
    v_mov_b32 v11, v23
    v_mov_b32 v22, 0
    v_mov_b32 v23, 0
    v_lshlrev_b32 v28, 16, v28
    v_lshlrev_b32 v29, 16, v29
    ds_read_b128 v[248:251], v82 offset:32768
    ds_read_b64_tr_b16 v[64:65], v86 offset:34816
    ds_read_b64_tr_b16 v[66:67], v86 offset:35328
    ds_read_b64_tr_b16 v[68:69], v86 offset:35840
    ds_read_b64_tr_b16 v[70:71], v86 offset:36352
    v_mfma_f32_32x32x16_bf16 v[96:111], v[48:51], v[240:243], v[96:111]
    v_mfma_f32_32x32x16_bf16 v[112:127], v[240:243], v[52:55], v[112:127]
    s_add_u32 s78, s78, 56320
    buffer_load_dwordx4 v11, s[16:19], s78 offen offset:2048 lds
    v_cvt_pk_bf16_f32 v46, v32, v32
    v_lshlrev_b32 v46, 16, v46
    v_sub_f32 v46, v32, v46
    v_cvt_pk_bf16_f32 v20, v32, v46
    v_and_b32 v47, 0xffff0000, v20
    v_sub_f32 v46, v46, v47
    v_cvt_pk_bf16_f32 v21, v46, 0
    s_nop 1
    v_mfma_f32_32x32x16_bf16 v[96:111], v[20:23], v[16:19], v[96:111]
    ds_read_b128 v[252:255], v83 offset:32768
    ds_read_b64_tr_b16 v[72:73], v87 offset:34816
    ds_read_b64_tr_b16 v[74:75], v87 offset:35328
    ds_read_b64_tr_b16 v[76:77], v87 offset:35840
    ds_read_b64_tr_b16 v[78:79], v87 offset:36352
    s_waitcnt lgkmcnt(12)
    v_mfma_f32_32x32x16_bf16 v[96:111], v[56:59], v[244:247], v[96:111]
    s_waitcnt lgkmcnt(10)
    v_mfma_f32_32x32x16_bf16 v[112:127], v[244:247], v[60:63], v[112:127]
    s_add_u32 s78, s78, 56320
    buffer_load_dwordx4 v11, s[16:19], s78 offen offset:3072 lds
    v_mul_f32 v10, v25, v25
    v_mul_f32 v24, 3222493025, v25
    v_mul_f32 v10, s93, v10
    v_mul_f32 v10, v10, v25
    v_lshlrev_b32 v3, 26, v0
    v_mov_b32 v4, 1
    v_cvt_pk_bf16_f32 v46, v33, v33
    v_lshlrev_b32 v46, 16, v46
    v_sub_f32 v46, v33, v46
    v_cvt_pk_bf16_f32 v20, v33, v46
    v_and_b32 v47, 0xffff0000, v20
    v_sub_f32 v46, v46, v47
    v_cvt_pk_bf16_f32 v21, v46, 0
    s_nop 1
    v_mfma_f32_32x32x16_bf16 v[112:127], v[16:19], v[20:23], v[112:127]
    s_waitcnt lgkmcnt(0)
    s_barrier
    ds_read_b64_tr_b16 v[48:49], v6 offset:0
    ds_read_b64_tr_b16 v[50:51], v6 offset:512
    ds_read_b64_tr_b16 v[52:53], v7 offset:0
    ds_read_b64_tr_b16 v[54:55], v7 offset:512
    v_mfma_f32_32x32x16_bf16 v[96:111], v[64:67], v[248:251], v[96:111]
    v_mfma_f32_32x32x16_bf16 v[112:127], v[248:251], v[68:71], v[112:127]
    s_bfe_u32 s60, s73, 0x10003
    s_xor_b32 s60, s60, 0
    s_add_u32 s60, s60, 2
    s_add_u32 m0, s55, 98304
    s_lshl_b32 s100, s60, 18
    buffer_load_dwordx4 v1, s[20:23], s100 offen offset:0 lds
    v_cvt_pk_bf16_f32 v46, v34, v34
    v_lshlrev_b32 v46, 16, v46
    v_sub_f32 v46, v34, v46
    v_cvt_pk_bf16_f32 v20, v34, v46
    v_and_b32 v47, 0xffff0000, v20
    v_sub_f32 v46, v46, v47
    v_cvt_pk_bf16_f32 v21, v46, v28
    s_nop 1
    v_mfma_f32_32x32x16_bf16 v[80:95], v[20:23], v[16:19], 0
    ds_read_b64_tr_b16 v[56:57], v8 offset:0
    ds_read_b64_tr_b16 v[58:59], v8 offset:512
    v_mfma_f32_32x32x16_bf16 v[96:111], v[72:75], v[252:255], v[96:111]
    v_mfma_f32_32x32x16_bf16 v[112:127], v[252:255], v[76:79], v[112:127]
    s_add_u32 s100, s100, 64512
    buffer_load_dwordx4 v1, s[20:23], s100 offen offset:1024 lds
    s_lshr_b32 s86, s55, 5
    s_add_u32 s86, s86, 149504
    v_lshl_add_u32 v12, v26, 2, s86
    v_lshl_add_u32 v13, v27, 4, s86
    ds_write_b32 v12, v25
    ds_read_b128 v[32:35], v13 offset:0
    ds_read_b128 v[36:39], v13 offset:32
    ds_read_b128 v[40:43], v13 offset:64
    ds_read_b128 v[44:47], v13 offset:96
    v_bfe_u32 v12, v0, 4, 1
    v_and_b32 v13, 15, v0
    v_lshl_add_u32 v13, v27, 4, v13
    v_lshlrev_b32 v13, 4, v13
    v_lshl_add_u32 v12, v12, 16, v13
    ds_read_b64_tr_b16 v[60:61], v9 offset:0
    ds_read_b64_tr_b16 v[62:63], v9 offset:512
    s_waitcnt lgkmcnt(11)
    v_mfma_f32_32x32x16_bf16 v[80:95], v[48:51], v[128:131], v[80:95]
    s_add_u32 s100, s100, 64512
    buffer_load_dwordx4 v1, s[20:23], s100 offen offset:2048 lds
    ds_read_b64_tr_b16 v[48:49], v6 offset:1024
    ds_read_b64_tr_b16 v[50:51], v6 offset:1536
    s_waitcnt lgkmcnt(11)
    v_mfma_f32_32x32x16_bf16 v[80:95], v[52:55], v[132:135], v[80:95]
    v_mul_f32 v96, v25, v96
    v_mul_f32 v97, v25, v97
    v_mul_f32 v98, v25, v98
    v_mul_f32 v99, v25, v99
    v_mul_f32 v100, v25, v100
    v_mul_f32 v101, v25, v101
    v_mul_f32 v102, v25, v102
    v_mul_f32 v103, v25, v103
    s_add_u32 s100, s100, 64512
    buffer_load_dwordx4 v1, s[20:23], s100 offen offset:3072 lds
    ds_read_b64_tr_b16 v[52:53], v7 offset:1024
    ds_read_b64_tr_b16 v[54:55], v7 offset:1536
    s_waitcnt lgkmcnt(11)
    v_mfma_f32_32x32x16_bf16 v[80:95], v[56:59], v[136:139], v[80:95]
    v_cvt_pk_bf16_f32 v96, v96, v97
    v_cvt_pk_bf16_f32 v97, v98, v99
    v_cvt_pk_bf16_f32 v98, v100, v101
    v_cvt_pk_bf16_f32 v99, v102, v103
    buffer_store_dwordx4 v[96:99], v15, s[28:31], s80 offen sc1
    v_mul_f32 v104, v25, v104
    v_mul_f32 v105, v25, v105
    v_mul_f32 v106, v25, v106
    ds_read_b64_tr_b16 v[56:57], v8 offset:1024
    ds_read_b64_tr_b16 v[58:59], v8 offset:1536
    s_waitcnt lgkmcnt(6)
    v_mfma_f32_32x32x16_bf16 v[80:95], v[60:63], v[140:143], v[80:95]
    v_mul_f32 v107, v25, v107
    v_mul_f32 v108, v25, v108
    v_mul_f32 v109, v25, v109
    v_mul_f32 v110, v25, v110
    v_mul_f32 v111, v25, v111
    v_cvt_pk_bf16_f32 v104, v104, v105
    v_cvt_pk_bf16_f32 v105, v106, v107
    ds_read_b64_tr_b16 v[60:61], v9 offset:1024
    ds_read_b64_tr_b16 v[62:63], v9 offset:1536
    s_waitcnt lgkmcnt(6)
    v_mfma_f32_32x32x16_bf16 v[80:95], v[48:51], v[144:147], v[80:95]
    v_cvt_pk_bf16_f32 v106, v108, v109
    v_cvt_pk_bf16_f32 v107, v110, v111
    s_add_u32 s80, s80, 65536
    buffer_store_dwordx4 v[104:107], v15, s[28:31], s80 offen sc1
    v_mul_f32 v112, v32, v112
    v_mul_f32 v113, v33, v113
    v_mul_f32 v114, v34, v114
    v_mul_f32 v115, v35, v115
    ds_read_b64_tr_b16 v[48:49], v6 offset:2048
    ds_read_b64_tr_b16 v[50:51], v6 offset:2560
    s_waitcnt lgkmcnt(6)
    v_mfma_f32_32x32x16_bf16 v[80:95], v[52:55], v[148:151], v[80:95]
    v_mul_f32 v116, v36, v116
    v_mul_f32 v117, v37, v117
    v_mul_f32 v118, v38, v118
    v_mul_f32 v119, v39, v119
    v_cvt_pk_bf16_f32 v112, v112, v113
    v_cvt_pk_bf16_f32 v113, v114, v115
    v_cvt_pk_bf16_f32 v114, v116, v117
    ds_read_b64_tr_b16 v[52:53], v7 offset:2048
    ds_read_b64_tr_b16 v[54:55], v7 offset:2560
    s_waitcnt lgkmcnt(6)
    v_mfma_f32_32x32x16_bf16 v[80:95], v[56:59], v[152:155], v[80:95]
    v_cvt_pk_bf16_f32 v115, v118, v119
    buffer_store_dwordx4 v[112:115], v12, s[28:31], s81 offen offset:0 sc1
    v_mul_f32 v120, v40, v120
    v_mul_f32 v121, v41, v121
    v_mul_f32 v122, v42, v122
    v_mul_f32 v123, v43, v123
    v_mul_f32 v124, v44, v124
    v_mul_f32 v125, v45, v125
    ds_read_b64_tr_b16 v[56:57], v8 offset:2048
    ds_read_b64_tr_b16 v[58:59], v8 offset:2560
    s_waitcnt lgkmcnt(6)
    v_mfma_f32_32x32x16_bf16 v[80:95], v[60:63], v[156:159], v[80:95]
    v_mul_f32 v126, v46, v126
    v_mul_f32 v127, v47, v127
    v_cvt_pk_bf16_f32 v120, v120, v121
    v_cvt_pk_bf16_f32 v121, v122, v123
    v_cvt_pk_bf16_f32 v122, v124, v125
    v_cvt_pk_bf16_f32 v123, v126, v127
    buffer_store_dwordx4 v[120:123], v12, s[28:31], s81 offen offset:512 sc1
    s_lshl_b32 s88, s97, 4
    v_xor_b32 v30, s88, v30
    v_add_u32 v21, 131072, v30
    ds_read_b128 v[32:35], v21 offset:6144
    ds_read_b128 v[36:39], v21 offset:6160
    ds_read_b64_tr_b16 v[60:61], v9 offset:2048
    ds_read_b64_tr_b16 v[62:63], v9 offset:2560
    s_waitcnt lgkmcnt(8)
    v_mfma_f32_32x32x16_bf16 v[80:95], v[48:51], v[160:163], v[80:95]
    s_lshl_b32 s88, s65, 1
    s_sub_u32 s88, s88, 2
    v_add_u32 v42, s88, v0
    v_lshlrev_b32 v42, 14, v42
    ds_read_b64_tr_b16 v[48:49], v6 offset:3072
    ds_read_b64_tr_b16 v[50:51], v6 offset:3584
    s_waitcnt lgkmcnt(8)
    v_mfma_f32_32x32x16_bf16 v[80:95], v[52:55], v[164:167], v[80:95]
    v_add_u32 v43, -32512, v42
    v_cmp_gt_u32 vcc, 4, v0
    s_nop 1
    v_cndmask_b32 v42, v43, v42, vcc
    s_lshr_b32 s89, s99, 2
    ds_read_b64_tr_b16 v[52:53], v7 offset:3072
    ds_read_b64_tr_b16 v[54:55], v7 offset:3584
    s_waitcnt lgkmcnt(8)
    v_mfma_f32_32x32x16_bf16 v[80:95], v[56:59], v[168:171], v[80:95]
    s_lshl_b32 s89, s89, 5
    s_add_u32 s89, s89, 15728640
    s_lshl_b32 s88, s48, 26
    s_add_u32 s89, s89, s88
    ds_read_b64_tr_b16 v[56:57], v8 offset:3072
    ds_read_b64_tr_b16 v[58:59], v8 offset:3584
    s_waitcnt lgkmcnt(6)
    v_mfma_f32_32x32x16_bf16 v[80:95], v[60:63], v[172:175], v[80:95]
    v_add_u32 v42, s89, v42
    v_cmp_le_u32 vcc, 6, v0
    v_mov_b32 v43, 0x40000000
    s_nop 0
    v_cndmask_b32 v42, v42, v43, vcc
    ds_read_b64_tr_b16 v[60:61], v9 offset:3072
    ds_read_b64_tr_b16 v[62:63], v9 offset:3584
    s_waitcnt lgkmcnt(6)
    v_mfma_f32_32x32x16_bf16 v[80:95], v[48:51], v[176:179], v[80:95]
    s_cmp_eq_u32 s65, 0
    s_cselect_b32 s68, 60, 63
    s_mov_b32 s69, 0
    s_waitcnt vmcnt(8)
    s_waitcnt lgkmcnt(0)
    s_barrier
    v_and_b32 v20, v33, v35
    v_and_b32 v20, v20, v37
    v_and_b32 v20, v20, v39
    v_cmp_ne_u32 vcc, 1, v20
    s_nop 0
    s_cmp_eq_u64 vcc, 0
    s_cbranch_scc1 GDOK_10
    s_mov_b32 s94, 0
GDLP_11:
    s_nop 0
    s_sleep 2
    buffer_load_dwordx4 v[32:35], v30, s[28:31], s59 offen sc1
    buffer_load_dwordx4 v[36:39], v30, s[28:31], s59 offen offset:16 sc1
    s_waitcnt vmcnt(0)
    s_add_u32 s94, s94, 1
    s_cmp_gt_u32 s94, 0x40000
    s_cbranch_scc1 GDOK_10
    v_and_b32 v20, v33, v35
    v_and_b32 v20, v20, v37
    v_and_b32 v20, v20, v39
    v_cmp_ne_u32 vcc, 1, v20
    s_nop 0
    s_cmp_eq_u64 vcc, 0
    s_cbranch_scc0 GDLP_11
    s_nop 1
GDOK_10:
    ds_read_b64_tr_b16 v[48:49], v6 offset:32768
    ds_read_b64_tr_b16 v[50:51], v6 offset:33280
    v_mfma_f32_32x32x16_bf16 v[80:95], v[52:55], v[180:183], v[80:95]
    v_add_f32 v32, v32, v34
    v_add_f32 v36, v36, v38
    v_add_f32 v32, v32, v36
    v_cvt_pk_bf16_f32 v46, v32, v32
    v_lshlrev_b32 v46, 16, v46
    v_sub_f32 v46, v32, v46
    ds_read_b64_tr_b16 v[52:53], v7 offset:32768
    ds_read_b64_tr_b16 v[54:55], v7 offset:33280
    v_mfma_f32_32x32x16_bf16 v[80:95], v[56:59], v[184:187], v[80:95]
    v_cvt_pk_bf16_f32 v20, v32, v46
    v_and_b32 v47, 0xffff0000, v20
    v_sub_f32 v46, v46, v47
    v_cvt_pk_bf16_f32 v21, v46, v29
    s_sub_u32 s88, s49, 1
    ds_read_b64_tr_b16 v[56:57], v8 offset:32768
    ds_read_b64_tr_b16 v[58:59], v8 offset:33280
    v_mfma_f32_32x32x16_bf16 v[80:95], v[60:63], v[188:191], v[80:95]
    v_and_b32 v20, s88, v20
    v_and_b32 v21, s88, v21
    s_nop 1
    v_mfma_f32_32x32x16_bf16 v[96:111], v[20:23], v[16:19], 0
    s_lshl1_add_u32 s88, s50, s49
    s_lshl_b32 s88, s88, 12
    s_add_u32 s88, s88, 131072
    ds_read_b64_tr_b16 v[60:61], v9 offset:32768
    ds_read_b64_tr_b16 v[62:63], v9 offset:33280
    s_waitcnt lgkmcnt(6)
    v_mfma_f32_32x32x16_bf16 v[80:95], v[48:51], v[192:195], v[80:95]
    v_add_u32 v40, s88, v15
    s_lshl_b32 s89, s49, 11
    s_sub_u32 s88, s88, s89
    v_add_u32 v41, s88, v15
    v_bfe_u32 v44, v0, 2, 2
    ds_read_b64_tr_b16 v[48:49], v6 offset:33792
    ds_read_b64_tr_b16 v[50:51], v6 offset:34304
    s_waitcnt lgkmcnt(6)
    v_mfma_f32_32x32x16_bf16 v[80:95], v[52:55], v[196:199], v[80:95]
    v_lshl_add_u32 v44, v27, 3, v44
    v_lshlrev_b32 v44, 6, v44
    v_bfe_u32 v45, v0, 4, 1
    v_lshl_add_u32 v44, v45, 5, v44
    v_and_b32 v45, 3, v0
    v_lshl_add_u32 v44, v45, 3, v44
    ds_read_b64_tr_b16 v[52:53], v7 offset:33792
    ds_read_b64_tr_b16 v[54:55], v7 offset:34304
    s_waitcnt lgkmcnt(6)
    v_mfma_f32_32x32x16_bf16 v[80:95], v[56:59], v[200:203], v[80:95]
    s_add_u32 s89, s89, 65536
    v_add_u32 v44, s89, v44
    v_bfe_u32 v39, v0, 2, 2
    v_lshl_add_u32 v38, v27, 2, v39
    v_lshlrev_b32 v38, 7, v38
    ds_read_b64_tr_b16 v[56:57], v8 offset:33792
    ds_read_b64_tr_b16 v[58:59], v8 offset:34304
    s_waitcnt lgkmcnt(6)
    v_mfma_f32_32x32x16_bf16 v[80:95], v[60:63], v[204:207], v[80:95]
    v_bfe_u32 v36, v0, 4, 1
    v_bfe_u32 v37, v0, 1, 1
    v_lshl_add_u32 v36, v36, 1, v37
    v_and_b32 v37, 2, v39
    v_lshlrev_b32 v37, 1, v37
    v_xor_b32 v36, v36, v37
    ds_read_b64_tr_b16 v[60:61], v9 offset:33792
    ds_read_b64_tr_b16 v[62:63], v9 offset:34304
    s_waitcnt lgkmcnt(6)
    v_mfma_f32_32x32x16_bf16 v[80:95], v[48:51], v[208:211], v[80:95]
    v_lshl_add_u32 v38, v36, 4, v38
    v_and_b32 v37, 1, v0
    v_lshl_add_u32 v38, v37, 3, v38
    s_lshl_b32 s87, s76, 10
    v_add_u32 v38, s87, v38
    s_waitcnt vmcnt(0)
    s_waitcnt lgkmcnt(0)
    s_barrier
    s_nop 3
    s_cmp_lg_u32 s48, 0
    s_cbranch_scc1 W0_12
    buffer_store_dword v4, v3, s[28:31], s92 offen offset:0 sc1
W0_12:
    ds_read_b64_tr_b16 v[48:49], v6 offset:34816
    ds_read_b64_tr_b16 v[50:51], v6 offset:35328
    v_mfma_f32_32x32x16_bf16 v[80:95], v[52:55], v[212:215], v[80:95]
    s_bfe_u32 s60, s73, 0x10003
    s_xor_b32 s60, s60, 1
    s_add_u32 s60, s60, 2
    s_add_u32 m0, s55, 0
    s_lshl_b32 s100, s60, 18
    buffer_load_dwordx4 v1, s[20:23], s100 offen offset:0 lds
    ds_read_b64_tr_b16 v[52:53], v7 offset:34816
    ds_read_b64_tr_b16 v[54:55], v7 offset:35328
    v_mfma_f32_32x32x16_bf16 v[80:95], v[56:59], v[216:219], v[80:95]
    ds_read_b64_tr_b16 v[56:57], v8 offset:34816
    ds_read_b64_tr_b16 v[58:59], v8 offset:35328
    v_mfma_f32_32x32x16_bf16 v[80:95], v[60:63], v[220:223], v[80:95]
    s_add_u32 s100, s100, 64512
    buffer_load_dwordx4 v1, s[20:23], s100 offen offset:1024 lds
    ds_read_b64_tr_b16 v[60:61], v9 offset:34816
    ds_read_b64_tr_b16 v[62:63], v9 offset:35328
    s_waitcnt lgkmcnt(6)
    v_mfma_f32_32x32x16_bf16 v[80:95], v[48:51], v[224:227], v[80:95]
    ds_read_b64_tr_b16 v[48:49], v6 offset:35840
    ds_read_b64_tr_b16 v[50:51], v6 offset:36352
    s_waitcnt lgkmcnt(6)
    v_mfma_f32_32x32x16_bf16 v[80:95], v[52:55], v[228:231], v[80:95]
    s_add_u32 s100, s100, 64512
    buffer_load_dwordx4 v1, s[20:23], s100 offen offset:2048 lds
    ds_read_b64_tr_b16 v[52:53], v7 offset:35840
    ds_read_b64_tr_b16 v[54:55], v7 offset:36352
    s_waitcnt lgkmcnt(6)
    v_mfma_f32_32x32x16_bf16 v[80:95], v[56:59], v[232:235], v[80:95]
    ds_read_b64_tr_b16 v[56:57], v8 offset:35840
    ds_read_b64_tr_b16 v[58:59], v8 offset:36352
    s_waitcnt lgkmcnt(6)
    v_mfma_f32_32x32x16_bf16 v[80:95], v[60:63], v[236:239], v[80:95]
    s_add_u32 s100, s100, 64512
    buffer_load_dwordx4 v1, s[20:23], s100 offen offset:3072 lds
    ds_read_b64_tr_b16 v[60:61], v9 offset:35840
    ds_read_b64_tr_b16 v[62:63], v9 offset:36352
    s_waitcnt lgkmcnt(6)
    v_mfma_f32_32x32x16_bf16 v[80:95], v[48:51], v[240:243], v[80:95]
    s_waitcnt lgkmcnt(0)
    s_barrier
    ds_read_b64_tr_b16 v[48:49], v44 offset:0
    ds_read_b64_tr_b16 v[50:51], v44 offset:256
    v_mfma_f32_32x32x16_bf16 v[80:95], v[52:55], v[244:247], v[80:95]
    ds_read_b64_tr_b16 v[52:53], v44 offset:1024
    ds_read_b64_tr_b16 v[54:55], v44 offset:1280
    s_and_b32 s60, s73, 7
    s_add_u32 s60, s60, 1
    s_lshl_b32 s60, s60, 2
    s_lshr_b64 s[60:61], s[40:41], s60
    s_and_b32 s60, s60, 15
    s_add_u32 m0, s55, 32768
    s_lshl_b32 s100, s60, 18
    buffer_load_dwordx4 v1, s[20:23], s100 offen offset:0 lds
    v_mfma_f32_32x32x16_bf16 v[80:95], v[56:59], v[248:251], v[80:95]
    ds_read_b64_tr_b16 v[56:57], v44 offset:4096
    ds_read_b64_tr_b16 v[58:59], v44 offset:4352
    s_add_u32 s100, s100, 64512
    buffer_load_dwordx4 v1, s[20:23], s100 offen offset:1024 lds
    v_mfma_f32_32x32x16_bf16 v[80:95], v[60:63], v[252:255], v[80:95]
    v_mov_b32 v6, v38
    v_xor_b32 v7, 64, v38
    v_add_u32 v12, 0x10000, v6
    v_add_u32 v13, 0x10000, v7
    v_add_u32 v22, 0x20000, v6
    v_add_u32 v23, 0x20000, v7
    ds_read_b64_tr_b16 v[60:61], v44 offset:5120
    ds_read_b64_tr_b16 v[62:63], v44 offset:5376
    s_waitcnt lgkmcnt(6)
    v_mfma_f32_32x32x16_bf16 v[96:111], v[48:51], v[128:131], v[96:111]
    s_nop 1
    v_mul_f32 v64, v80, v80
    v_mul_f32 v65, v81, v81
    v_mul_f32 v66, v82, v82
    v_mul_f32 v67, v83, v83
    ds_read_b64_tr_b16 v[48:49], v44 offset:8192
    ds_read_b64_tr_b16 v[50:51], v44 offset:8448
    s_waitcnt lgkmcnt(6)
    v_mfma_f32_32x32x16_bf16 v[96:111], v[52:55], v[132:135], v[96:111]
    v_mul_f32 v68, v84, v84
    v_mul_f32 v69, v85, v85
    v_mul_f32 v70, v86, v86
    v_mul_f32 v71, v87, v87
    s_add_u32 s100, s100, 64512
    buffer_load_dwordx4 v1, s[20:23], s100 offen offset:2048 lds
    ds_read_b64_tr_b16 v[52:53], v44 offset:9216
    ds_read_b64_tr_b16 v[54:55], v44 offset:9472
    s_waitcnt lgkmcnt(6)
    v_mfma_f32_32x32x16_bf16 v[96:111], v[56:59], v[144:147], v[96:111]
    v_fma_f32 v64, v64, v10, v24
    v_fma_f32 v65, v65, v10, v24
    v_fma_f32 v66, v66, v10, v24
    v_fma_f32 v67, v67, v10, v24
    ds_read_b64_tr_b16 v[56:57], v44 offset:12288
    ds_read_b64_tr_b16 v[58:59], v44 offset:12544
    s_waitcnt lgkmcnt(6)
    v_mfma_f32_32x32x16_bf16 v[96:111], v[60:63], v[148:151], v[96:111]
    v_fma_f32 v68, v68, v10, v24
    v_fma_f32 v69, v69, v10, v24
    v_fma_f32 v70, v70, v10, v24
    v_fma_f32 v71, v71, v10, v24
    ds_read_b64_tr_b16 v[60:61], v44 offset:13312
    ds_read_b64_tr_b16 v[62:63], v44 offset:13568
    s_waitcnt lgkmcnt(6)
    v_mfma_f32_32x32x16_bf16 v[96:111], v[48:51], v[160:163], v[96:111]
    v_mul_f32 v64, v64, v80
    v_mul_f32 v65, v65, v81
    v_mul_f32 v66, v66, v82
    v_mul_f32 v67, v67, v83
    s_add_u32 s100, s100, 64512
    buffer_load_dwordx4 v1, s[20:23], s100 offen offset:3072 lds
    ds_read_b64_tr_b16 v[48:49], v44 offset:16384
    ds_read_b64_tr_b16 v[50:51], v44 offset:16640
    s_waitcnt lgkmcnt(6)
    v_mfma_f32_32x32x16_bf16 v[96:111], v[52:55], v[164:167], v[96:111]
    v_mul_f32 v68, v68, v84
    v_mul_f32 v69, v69, v85
    v_mul_f32 v70, v70, v86
    ds_read_b64_tr_b16 v[52:53], v44 offset:17408
    ds_read_b64_tr_b16 v[54:55], v44 offset:17664
    s_waitcnt lgkmcnt(6)
    v_mfma_f32_32x32x16_bf16 v[96:111], v[56:59], v[176:179], v[96:111]
    v_mul_f32 v71, v71, v87
    v_exp_f32 v64, v64
    v_exp_f32 v65, v65
    v_exp_f32 v66, v66
    ds_read_b64_tr_b16 v[56:57], v44 offset:20480
    ds_read_b64_tr_b16 v[58:59], v44 offset:20736
    s_waitcnt lgkmcnt(6)
    v_mfma_f32_32x32x16_bf16 v[96:111], v[60:63], v[180:183], v[96:111]
    v_exp_f32 v67, v67
    v_exp_f32 v68, v68
    v_exp_f32 v69, v69
    v_exp_f32 v70, v70
    ds_read_b64_tr_b16 v[60:61], v44 offset:21504
    ds_read_b64_tr_b16 v[62:63], v44 offset:21760
    s_waitcnt lgkmcnt(6)
    v_mfma_f32_32x32x16_bf16 v[96:111], v[48:51], v[192:195], v[96:111]
    v_exp_f32 v71, v71
    v_fma_f32 v64, v64, v2, v2
    v_fma_f32 v65, v65, v2, v2
    v_fma_f32 v66, v66, v2, v2
    buffer_load_dword v43, v42, s[28:31], 0 offen offset:0 sc1
    ds_read_b64_tr_b16 v[48:49], v44 offset:24576
    ds_read_b64_tr_b16 v[50:51], v44 offset:24832
    s_waitcnt lgkmcnt(6)
    v_mfma_f32_32x32x16_bf16 v[96:111], v[52:55], v[196:199], v[96:111]
    v_fma_f32 v67, v67, v2, v2
    v_fma_f32 v68, v68, v2, v2
    v_fma_f32 v69, v69, v2, v2
    v_fma_f32 v70, v70, v2, v2
    ds_read_b64_tr_b16 v[52:53], v44 offset:25600
    ds_read_b64_tr_b16 v[54:55], v44 offset:25856
    s_waitcnt lgkmcnt(6)
    v_mfma_f32_32x32x16_bf16 v[96:111], v[56:59], v[208:211], v[96:111]
    v_fma_f32 v71, v71, v2, v2
    v_rcp_f32 v64, v64
    v_rcp_f32 v65, v65
    ds_read_b64_tr_b16 v[56:57], v44 offset:28672
    ds_read_b64_tr_b16 v[58:59], v44 offset:28928
    s_waitcnt lgkmcnt(6)
    v_mfma_f32_32x32x16_bf16 v[96:111], v[60:63], v[212:215], v[96:111]
    v_rcp_f32 v66, v66
    v_rcp_f32 v67, v67
    v_rcp_f32 v68, v68
    v_rcp_f32 v69, v69
    ds_read_b64_tr_b16 v[60:61], v44 offset:29696
    ds_read_b64_tr_b16 v[62:63], v44 offset:29952
    s_waitcnt lgkmcnt(6)
    v_mfma_f32_32x32x16_bf16 v[96:111], v[48:51], v[224:227], v[96:111]
    v_rcp_f32 v70, v70
    v_rcp_f32 v71, v71
    v_mul_f32 v80, v80, v64
    v_mul_f32 v81, v81, v65
    s_waitcnt lgkmcnt(4)
    v_mfma_f32_32x32x16_bf16 v[96:111], v[52:55], v[228:231], v[96:111]
    v_mul_f32 v82, v82, v66
    v_mul_f32 v83, v83, v67
    v_mul_f32 v84, v84, v68
    v_mul_f32 v85, v85, v69
    s_waitcnt lgkmcnt(2)
    v_mfma_f32_32x32x16_bf16 v[96:111], v[56:59], v[240:243], v[96:111]
    v_mul_f32 v86, v86, v70
    v_mul_f32 v87, v87, v71
    v_cvt_pk_bf16_f32 v80, v80, v81
    v_cvt_pk_bf16_f32 v81, v82, v83
    s_waitcnt lgkmcnt(0)
    v_mfma_f32_32x32x16_bf16 v[96:111], v[60:63], v[244:247], v[96:111]
    v_cvt_pk_bf16_f32 v82, v84, v85
    v_cvt_pk_bf16_f32 v83, v86, v87
    buffer_store_dwordx4 v[80:83], v15, s[28:31], s82 offen offset:0 sc1
    v_mul_f32 v64, v88, v88
    v_mul_f32 v65, v89, v89
    v_mul_f32 v66, v90, v90
    v_mul_f32 v67, v91, v91
    v_mul_f32 v68, v92, v92
    v_mul_f32 v69, v93, v93
    v_mul_f32 v70, v94, v94
    v_mul_f32 v71, v95, v95
    v_fma_f32 v64, v64, v10, v24
    v_fma_f32 v65, v65, v10, v24
    v_fma_f32 v66, v66, v10, v24
    v_fma_f32 v67, v67, v10, v24
    v_fma_f32 v68, v68, v10, v24
    v_fma_f32 v69, v69, v10, v24
    v_fma_f32 v70, v70, v10, v24
    ds_write_b128 v40, v[96:99] offset:0
    ds_write_b128 v40, v[100:103] offset:1024
    ds_write_b128 v40, v[104:107] offset:2048
    ds_write_b128 v40, v[108:111] offset:3072
    s_waitcnt vmcnt(6)
    s_waitcnt lgkmcnt(0)
    s_barrier
    ds_read_b128 v[96:99], v41
    ds_read_b128 v[100:103], v41 offset:1024
    ds_read_b128 v[104:107], v41 offset:4096
    ds_read_b128 v[108:111], v41 offset:5120
    v_fma_f32 v71, v71, v10, v24
    s_and_b32 s60, s73, 7
    s_add_u32 s60, s60, 0
    s_lshl_b32 s60, s60, 2
    s_lshr_b64 s[60:61], s[40:41], s60
    s_and_b32 s60, s60, 15
    s_add_u32 m0, s55, 65536
    s_lshl_b32 s100, s60, 18
    buffer_load_dwordx4 v1, s[20:23], s100 offen offset:0 lds
    v_mul_f32 v64, v64, v88
    s_add_u32 s100, s100, 64512
    buffer_load_dwordx4 v1, s[20:23], s100 offen offset:1024 lds
    v_mul_f32 v65, v65, v89
    s_add_u32 s100, s100, 64512
    buffer_load_dwordx4 v1, s[20:23], s100 offen offset:2048 lds
    v_mul_f32 v66, v66, v90
    s_add_u32 s100, s100, 64512
    buffer_load_dwordx4 v1, s[20:23], s100 offen offset:3072 lds
    v_mul_f32 v67, v67, v91
    ds_read_b64_tr_b16 v[192:193], v12 offset:32768
    v_mul_f32 v68, v68, v92
    ds_read_b64_tr_b16 v[194:195], v12 offset:36864
    v_mul_f32 v69, v69, v93
    ds_read_b64_tr_b16 v[196:197], v13 offset:32768
    v_mul_f32 v70, v70, v94
    ds_read_b64_tr_b16 v[198:199], v13 offset:36864
    v_mul_f32 v71, v71, v95
    ds_read_b64_tr_b16 v[200:201], v12 offset:40960
    v_exp_f32 v64, v64
    ds_read_b64_tr_b16 v[202:203], v12 offset:45056
    v_exp_f32 v65, v65
    ds_read_b64_tr_b16 v[204:205], v13 offset:40960
    v_exp_f32 v66, v66
    ds_read_b64_tr_b16 v[206:207], v13 offset:45056
    v_exp_f32 v67, v67
    ds_read_b64_tr_b16 v[208:209], v12 offset:49152
    v_exp_f32 v68, v68
    ds_read_b64_tr_b16 v[210:211], v12 offset:53248
    v_exp_f32 v69, v69
    ds_read_b64_tr_b16 v[212:213], v13 offset:49152
    v_exp_f32 v70, v70
    ds_read_b64_tr_b16 v[214:215], v13 offset:53248
    v_exp_f32 v71, v71
    ds_read_b64_tr_b16 v[216:217], v12 offset:57344
    v_fma_f32 v64, v64, v2, v2
    ds_read_b64_tr_b16 v[218:219], v12 offset:61440
    v_fma_f32 v65, v65, v2, v2
    ds_read_b64_tr_b16 v[220:221], v13 offset:57344
    v_fma_f32 v66, v66, v2, v2
    ds_read_b64_tr_b16 v[222:223], v13 offset:61440
    v_fma_f32 v67, v67, v2, v2
    ds_read_b64_tr_b16 v[224:225], v6 offset:0
    v_fma_f32 v68, v68, v2, v2
    ds_read_b64_tr_b16 v[226:227], v6 offset:4096
    v_fma_f32 v69, v69, v2, v2
    ds_read_b64_tr_b16 v[228:229], v7 offset:0
    v_fma_f32 v70, v70, v2, v2
    ds_read_b64_tr_b16 v[230:231], v7 offset:4096
    v_fma_f32 v71, v71, v2, v2
    ds_read_b64_tr_b16 v[232:233], v6 offset:8192
    v_rcp_f32 v64, v64
    ds_read_b64_tr_b16 v[234:235], v6 offset:12288
    v_rcp_f32 v65, v65
    ds_read_b64_tr_b16 v[236:237], v7 offset:8192
    v_rcp_f32 v66, v66
    ds_read_b64_tr_b16 v[238:239], v7 offset:12288
    v_rcp_f32 v67, v67
    ds_read_b64_tr_b16 v[240:241], v6 offset:16384
    v_rcp_f32 v68, v68
    ds_read_b64_tr_b16 v[242:243], v6 offset:20480
    v_rcp_f32 v69, v69
    ds_read_b64_tr_b16 v[244:245], v7 offset:16384
    v_rcp_f32 v70, v70
    ds_read_b64_tr_b16 v[246:247], v7 offset:20480
    v_rcp_f32 v71, v71
    ds_read_b64_tr_b16 v[248:249], v6 offset:24576
    v_mul_f32 v88, v88, v64
    ds_read_b64_tr_b16 v[250:251], v6 offset:28672
    v_mul_f32 v89, v89, v65
    ds_read_b64_tr_b16 v[252:253], v7 offset:24576
    v_mul_f32 v90, v90, v66
    ds_read_b64_tr_b16 v[254:255], v7 offset:28672
    v_mul_f32 v91, v91, v67
    v_mul_f32 v92, v92, v68
    v_mul_f32 v93, v93, v69
    v_mul_f32 v94, v94, v70
    v_mul_f32 v95, v95, v71
    v_cvt_pk_bf16_f32 v88, v88, v89
    v_cvt_pk_bf16_f32 v89, v90, v91
    v_cvt_pk_bf16_f32 v90, v92, v93
    v_cvt_pk_bf16_f32 v91, v94, v95
    buffer_store_dwordx4 v[88:91], v15, s[28:31], s82 offen offset:1024 sc1
    s_nop 1
    s_cmp_lg_u32 s48, 0
    s_cbranch_scc1 W0_13
    s_waitcnt vmcnt(6)
    v_cmp_ne_u32 vcc, 1, v43
    s_nop 0
    s_andn2_b64 vcc, s[68:69], vcc
    s_cmp_eq_u64 vcc, s[68:69]
    s_cbranch_scc1 KVOK_14
    s_mov_b32 s94, 0
KVLP_15:
    s_sleep 2
    buffer_load_dword v43, v42, s[28:31], 0 offen offset:0 sc1
    s_waitcnt vmcnt(0)
    s_add_u32 s94, s94, 1
    s_cmp_gt_u32 s94, 0x40000
    s_cbranch_scc1 KVOK_14
    v_cmp_ne_u32 vcc, 1, v43
    s_nop 0
    s_andn2_b64 vcc, s[68:69], vcc
    s_cmp_eq_u64 vcc, s[68:69]
    s_cbranch_scc0 KVLP_15
KVOK_14:
W0_13:
    s_waitcnt lgkmcnt(0)
    s_barrier
    s_add_u32 s89, s66, 2097152
    buffer_load_dwordx4 v[112:115], v15, s[28:31], s66 offen sc1
    buffer_load_dwordx4 v[116:119], v15, s[28:31], s66 offen offset:1024 sc1
    buffer_load_dwordx4 v[32:35], v15, s[28:31], s67 offen sc1
    buffer_load_dwordx4 v[120:123], v15, s[28:31], s89 offen sc1
    buffer_load_dwordx4 v[124:127], v15, s[28:31], s89 offen offset:1024 sc1
    v_add_f32 v96, v96, v104
    v_add_f32 v97, v97, v105
    v_add_f32 v98, v98, v106
    v_add_f32 v99, v99, v107
    v_add_f32 v100, v100, v108
    v_add_f32 v101, v101, v109
    v_add_f32 v102, v102, v110
    v_add_f32 v103, v103, v111
    v_mul_f32 v64, v96, v96
    v_mul_f32 v65, v97, v97
    v_mul_f32 v66, v98, v98
    v_mul_f32 v67, v99, v99
    v_mul_f32 v68, v100, v100
    v_mul_f32 v69, v101, v101
    v_mul_f32 v70, v102, v102
    v_mul_f32 v71, v103, v103
    v_fma_f32 v64, v64, v10, v24
    v_fma_f32 v65, v65, v10, v24
    v_fma_f32 v66, v66, v10, v24
    v_fma_f32 v67, v67, v10, v24
    v_fma_f32 v68, v68, v10, v24
    v_fma_f32 v69, v69, v10, v24
    v_fma_f32 v70, v70, v10, v24
    v_fma_f32 v71, v71, v10, v24
    v_mul_f32 v64, v64, v96
    v_mul_f32 v65, v65, v97
    v_mul_f32 v66, v66, v98
    v_mul_f32 v67, v67, v99
    v_mul_f32 v68, v68, v100
    v_mul_f32 v69, v69, v101
    v_mul_f32 v70, v70, v102
    v_mul_f32 v71, v71, v103
    v_exp_f32 v64, v64
    v_exp_f32 v65, v65
    v_exp_f32 v66, v66
    v_exp_f32 v67, v67
    v_exp_f32 v68, v68
    v_exp_f32 v69, v69
    v_exp_f32 v70, v70
    v_exp_f32 v71, v71
    v_fma_f32 v64, v64, v2, v2
    v_fma_f32 v65, v65, v2, v2
    v_fma_f32 v66, v66, v2, v2
    v_fma_f32 v67, v67, v2, v2
    v_fma_f32 v68, v68, v2, v2
    v_fma_f32 v69, v69, v2, v2
    v_fma_f32 v70, v70, v2, v2
    v_fma_f32 v71, v71, v2, v2
    v_rcp_f32 v64, v64
    v_rcp_f32 v65, v65
    v_rcp_f32 v66, v66
    v_rcp_f32 v67, v67
    v_rcp_f32 v68, v68
    v_rcp_f32 v69, v69
    v_rcp_f32 v70, v70
    v_rcp_f32 v71, v71
    v_mul_f32 v96, v96, v64
    v_mul_f32 v97, v97, v65
    v_mul_f32 v98, v98, v66
    v_mul_f32 v99, v99, v67
    v_mul_f32 v100, v100, v68
    v_mul_f32 v101, v101, v69
    v_mul_f32 v102, v102, v70
    v_mul_f32 v103, v103, v71
    v_cvt_pk_bf16_f32 v96, v96, v97
    v_cvt_pk_bf16_f32 v97, v98, v99
    v_cvt_pk_bf16_f32 v98, v100, v101
    v_cvt_pk_bf16_f32 v99, v102, v103
    buffer_store_dwordx4 v[96:99], v15, s[28:31], s83 offen offset:0 sc1
    s_waitcnt lgkmcnt(0)
    s_nop 0
    s_add_u32 s92, s92, 768
    s_branch L_att
L_type2:
    s_lshl_b32 s56, s52, 7
    s_add_u32 s57, s56, 1024
    s_add_u32 s58, s56, 2048
    s_add_u32 s88, s56, 2048
    v_add_u32 v12, s88, v37
    v_add_u32 v13, s88, v38
    s_lshl_b32 s60, s90, 10
    buffer_load_dwordx4 v[240:243], v15, s[8:11], s60 offen
    s_cmp_ge_u32 s101, 24
    s_cselect_b32 s80, s16, s12
    s_cselect_b32 s81, s17, s13
    s_cselect_b32 s82, s18, s14
    s_mov_b32 s83, 0x20000
    s_cselect_b32 s61, 24, 0
    s_sub_u32 s61, s101, s61
    s_lshl_b32 s61, s61, 7
    s_lshl_b32 s60, s98, 7
    s_mul_i32 s60, s60, s3
    s_add_u32 s60, s60, s61
    s_add_u32 s60, s60, 4096
    s_lshl3_add_u32 s61, s3, s60
    s_sub_u32 s61, s61, 1024
    s_lshr_b32 s86, s55, 1
    s_add_u32 m0, s86, 131072
    s_nop 0
    buffer_load_dwordx4 v20, s[80:83], s60 offen lds
    buffer_load_dwordx4 v20, s[80:83], s61 offen offset:1024 lds
    s_lshr_b32 s60, s2, 3
    s_lshr_b32 s61, s2, 6
    s_lshl1_add_u32 s60, s61, s60
    s_and_b32 s60, s60, 7
    s_lshl_b32 s3, s60, 7
    s_add_u32 m0, s55, 0
    s_movk_i32 s62, 0
    buffer_load_dwordx4 v10, s[8:11], s62 offen lds
    buffer_load_dwordx4 v11, s[8:11], s62 offen offset:1024 lds
    s_mov_b32 s63, 0
    buffer_load_dwordx4 v12, s[12:15], s63 offen offset:2048 lds
    s_mov_b32 s63, 0
    buffer_load_dwordx4 v13, s[16:19], s63 offen offset:3072 lds
    v_and_b32 v26, 31, v0
    v_lshrrev_b32 v27, 5, v0
    v_bfe_u32 v34, v26, 1, 3
    v_xor_b32 v34, v34, v27
    v_lshlrev_b32 v34, 4, v34
    v_and_b32 v35, 15, v0
    v_lshl_add_u32 v34, v35, 7, v34
    v_bfe_u32 v35, v0, 4, 1
    v_lshl_add_u32 v34, v35, 12, v34
    s_lshl_b32 s88, s50, 13
    s_lshl_b32 s89, s49, 6
    s_or_b32 s88, s88, s89
    v_xor_b32 v34, s88, v34
    v_bfe_u32 v36, v0, 2, 2
    v_bfe_u32 v33, v0, 1, 1
    v_lshl_add_u32 v32, v35, 1, v33
    v_and_b32 v33, 2, v36
    v_lshlrev_b32 v33, 1, v33
    v_xor_b32 v32, v32, v33
    v_lshlrev_b32 v32, 4, v32
    s_add_u32 m0, s55, 32768
    s_movk_i32 s62, 128
    buffer_load_dwordx4 v10, s[8:11], s62 offen lds
    v_and_b32 v33, 1, v0
    v_lshl_add_u32 v32, v33, 3, v32
    v_lshl_add_u32 v32, v36, 7, v32
    v_lshl_add_u32 v250, v27, 10, v32
    s_lshr_b32 s88, s55, 1
    s_add_u32 s88, s88, 131072
    v_add_u32 v250, s88, v250
    v_xor_b32 v251, 64, v250
    v_lshl_add_u32 v35, v27, 12, v32
    s_lshl_b32 s88, s49, 14
    s_or_b32 s88, s88, s89
    v_xor_b32 v35, s88, v35
    v_xor_b32 v2, 0, v34
    v_xor_b32 v6, 0, v35
    v_add_u32 v80, 0x10000, v2
    v_add_u32 v84, 0x10000, v6
    v_xor_b32 v3, 32, v34
    v_xor_b32 v7, 8192, v35
    v_add_u32 v81, 0x10000, v3
    v_add_u32 v85, 0x10000, v7
    buffer_load_dwordx4 v11, s[8:11], s62 offen offset:1024 lds
    v_xor_b32 v4, 64, v34
    v_xor_b32 v8, 16384, v35
    v_add_u32 v82, 0x10000, v4
    v_add_u32 v86, 0x10000, v8
    v_xor_b32 v5, 96, v34
    v_xor_b32 v9, 24576, v35
    v_add_u32 v83, 0x10000, v5
    v_add_u32 v87, 0x10000, v9
    s_mov_b32 s93, 3184710632
    v_mov_b32 v18, 0
    v_mov_b32 v19, 0
    s_lshl_b32 s88, s49, 10
    v_lshl_add_u32 v30, v26, 5, s88
    s_lshl_b32 s92, s51, 14
    s_lshl_b32 s89, s52, 5
    s_add_u32 s92, s92, s89
    s_add_u32 s92, s92, 15728640
    s_lshr_b32 s61, s90, 7
    s_lshl_b32 s61, s61, 14
    s_and_b32 s60, s90, 127
    s_mov_b32 s63, 196608
    buffer_load_dwordx4 v12, s[12:15], s63 offen offset:2048 lds
    s_lshl3_add_u32 s60, s60, s61
    s_add_u32 s60, s60, 15735808
    v_lshl_add_u32 v252, v0, 26, s60
    s_lshl_b32 s60, s48, 2
    s_add_u32 s60, s60, 147456
    v_lshl_add_u32 v253, v0, 5, s60
    v_lshlrev_b32 v254, 5, v0
    v_add_u32 v254, 147456, v254
    v_and_b32 v248, 15, v0
    v_lshlrev_b32 v248, 2, v248
    s_lshr_b32 s86, s101, 2
    s_lshl_b32 s86, s86, 14
    s_and_b32 s87, s101, 3
    s_lshl_b32 s87, s87, 11
    s_add_u32 s86, s86, s87
    s_lshl3_add_u32 s86, s98, s86
    s_add_u32 s86, s86, 15736832
    s_cmp_ge_u32 s101, 52
    s_cselect_b32 s87, 1, s48
    s_lshl_b32 s87, s87, 26
    s_mov_b32 s63, 229376
    buffer_load_dwordx4 v13, s[16:19], s63 offen offset:3072 lds
    s_add_u32 s86, s86, s87
    v_lshl_add_u32 v255, v0, 5, s86
    s_add_u32 m0, s55, 65536
    s_movk_i32 s62, 256
    buffer_load_dwordx4 v10, s[8:11], s62 offen lds
    buffer_load_dwordx4 v11, s[8:11], s62 offen offset:1024 lds
    s_mov_b32 s63, 393216
    buffer_load_dwordx4 v12, s[12:15], s63 offen offset:2048 lds
    s_mov_b32 s63, 458752
    buffer_load_dwordx4 v13, s[16:19], s63 offen offset:3072 lds
    s_waitcnt vmcnt(15)
    s_cmp_eq_u32 s49, 1
    s_cbranch_scc1 NOPRIO_16
    s_setprio 1
NOPRIO_16:
    s_waitcnt vmcnt(8)
    s_barrier
    ds_read_b128 v[128:131], v2 offset:0
    ds_read_b64_tr_b16 v[48:49], v6 offset:2048
    ds_read_b64_tr_b16 v[50:51], v6 offset:2560
    ds_read_b64_tr_b16 v[52:53], v6 offset:3072
    ds_read_b64_tr_b16 v[54:55], v6 offset:3584
    ds_read_b128 v[132:135], v3 offset:0
    ds_read_b64_tr_b16 v[56:57], v7 offset:2048
    ds_read_b64_tr_b16 v[58:59], v7 offset:2560
    ds_read_b64_tr_b16 v[60:61], v7 offset:3072
    ds_read_b64_tr_b16 v[62:63], v7 offset:3584
    ds_read_b128 v[136:139], v4 offset:0
    ds_read_b64_tr_b16 v[64:65], v8 offset:2048
    ds_read_b64_tr_b16 v[66:67], v8 offset:2560
    ds_read_b64_tr_b16 v[68:69], v8 offset:3072
    ds_read_b64_tr_b16 v[70:71], v8 offset:3584
    s_waitcnt lgkmcnt(12)
    v_mfma_f32_32x32x16_bf16 v[96:111], v[48:51], v[128:131], 0
    s_waitcnt lgkmcnt(10)
    v_mfma_f32_32x32x16_bf16 v[112:127], v[52:55], v[128:131], 0
    s_add_u32 m0, s55, 98304
    s_movk_i32 s62, 384
    buffer_load_dwordx4 v10, s[8:11], s62 offen lds
    ds_read_b64_tr_b16 v[232:233], v250
    ds_read_b64_tr_b16 v[234:235], v250 offset:512
    ds_read_b64_tr_b16 v[236:237], v251
    ds_read_b64_tr_b16 v[238:239], v251 offset:512
    v_dot2_f32_bf16 v244, v240, v14, 0
    v_dot2_f32_bf16 v245, v240, v240, 0
    v_dot2_f32_bf16 v244, v241, v14, v244
    v_dot2_f32_bf16 v245, v241, v241, v245
    v_dot2_f32_bf16 v244, v242, v14, v244
    v_dot2_f32_bf16 v245, v242, v242, v245
    v_dot2_f32_bf16 v244, v243, v14, v244
    v_dot2_f32_bf16 v245, v243, v243, v245
    s_waitcnt lgkmcnt(3)
    v_dot2_f32_bf16 v228, v232, v14, 0
    s_waitcnt lgkmcnt(1)
    v_dot2_f32_bf16 v229, v236, v14, 0
    v_dot2_f32_bf16 v228, v233, v14, v228
    v_dot2_f32_bf16 v229, v237, v14, v229
    v_dot2_f32_bf16 v228, v234, v14, v228
    s_waitcnt lgkmcnt(0)
    v_dot2_f32_bf16 v229, v238, v14, v229
    v_dot2_f32_bf16 v228, v235, v14, v228
    v_dot2_f32_bf16 v229, v239, v14, v229
    v_add_f32_dpp v244, v244, v244 quad_perm:[1,0,3,2] row_mask:0xf bank_mask:0xf
    v_add_f32_dpp v245, v245, v245 quad_perm:[1,0,3,2] row_mask:0xf bank_mask:0xf
    s_nop 0
    v_permlane32_swap_b32 v228, v229
    v_add_f32 v228, v228, v229
    ds_write_b32 v253, v228
    v_add_f32_dpp v244, v244, v244 quad_perm:[2,3,0,1] row_mask:0xf bank_mask:0xf
    v_add_f32_dpp v245, v245, v245 quad_perm:[2,3,0,1] row_mask:0xf bank_mask:0xf
    ds_read_b128 v[140:143], v5 offset:0
    ds_read_b64_tr_b16 v[72:73], v9 offset:2048
    ds_read_b64_tr_b16 v[74:75], v9 offset:2560
    ds_read_b64_tr_b16 v[76:77], v9 offset:3072
    ds_read_b64_tr_b16 v[78:79], v9 offset:3584
    v_mfma_f32_32x32x16_bf16 v[96:111], v[56:59], v[132:135], v[96:111]
    v_mfma_f32_32x32x16_bf16 v[112:127], v[60:63], v[132:135], v[112:127]
    buffer_load_dwordx4 v11, s[8:11], s62 offen offset:1024 lds
    v_add_f32_dpp v244, v244, v244 row_half_mirror row_mask:0xf bank_mask:0xf
    v_add_f32_dpp v245, v245, v245 row_half_mirror row_mask:0xf bank_mask:0xf
    s_nop 0
    v_add_f32_dpp v244, v244, v244 row_mirror row_mask:0xf bank_mask:0xf
    v_add_f32_dpp v245, v245, v245 row_mirror row_mask:0xf bank_mask:0xf
    v_mov_b32 v246, v244
    v_mov_b32 v247, v245
    s_nop 0
    v_permlane16_swap_b32 v244, v246
    v_permlane16_swap_b32 v245, v247
    v_add_f32 v244, v244, v246
    v_add_f32 v245, v245, v247
    v_mov_b32 v246, v244
    v_mov_b32 v247, v245
    s_nop 0
    v_permlane32_swap_b32 v244, v246
    v_permlane32_swap_b32 v245, v247
    v_add_f32 v244, v244, v246
    v_add_f32 v245, v245, v247
    v_mul_f32 v244, 989855744, v244
    v_mul_f32 v245, 989855744, v245
    v_fma_f32 v245, -v244, v244, v245
    v_max_f32 v245, 0, v245
    v_cvt_pk_bf16_f32 v246, v245, v245
    v_lshlrev_b32 v246, 16, v246
    v_add_f32 v246, 925353388, v246
    v_cvt_pk_bf16_f32 v246, v246, v246
    v_lshlrev_b32 v246, 16, v246
    v_sqrt_f32 v246, v246
    s_nop 0
    v_cvt_pk_bf16_f32 v240, -v244, v246
    v_mov_b32 v241, 1
    s_waitcnt vmcnt(6)
    s_waitcnt lgkmcnt(0)
    s_barrier
    ds_read_b128 v[144:147], v2 offset:32768
    ds_read_b64_tr_b16 v[48:49], v6 offset:34816
    ds_read_b64_tr_b16 v[50:51], v6 offset:35328
    ds_read_b64_tr_b16 v[52:53], v6 offset:35840
    ds_read_b64_tr_b16 v[54:55], v6 offset:36352
    v_mfma_f32_32x32x16_bf16 v[96:111], v[64:67], v[136:139], v[96:111]
    s_mov_b32 s63, 589824
    buffer_load_dwordx4 v12, s[12:15], s63 offen offset:2048 lds
    v_mfma_f32_32x32x16_bf16 v[112:127], v[68:71], v[136:139], v[112:127]
    s_mov_b32 s63, 688128
    buffer_load_dwordx4 v13, s[16:19], s63 offen offset:3072 lds
    ds_read_b128 v[232:235], v254
    ds_read_b128 v[236:239], v254 offset:16
    s_waitcnt lgkmcnt(1)
    v_add_f32 v232, v232, v233
    v_add_f32 v234, v234, v235
    s_waitcnt lgkmcnt(0)
    v_add_f32 v236, v236, v237
    v_add_f32 v238, v238, v239
    v_add_f32 v232, v232, v234
    v_add_f32 v236, v236, v238
    v_add_f32 v244, v232, v236
    v_mov_b32 v245, 1
    ds_read_b128 v[148:151], v3 offset:32768
    ds_read_b64_tr_b16 v[56:57], v7 offset:34816
    ds_read_b64_tr_b16 v[58:59], v7 offset:35328
    ds_read_b64_tr_b16 v[60:61], v7 offset:35840
    ds_read_b64_tr_b16 v[62:63], v7 offset:36352
    v_mfma_f32_32x32x16_bf16 v[96:111], v[72:75], v[140:143], v[96:111]
    v_mfma_f32_32x32x16_bf16 v[112:127], v[76:79], v[140:143], v[112:127]
    s_add_u32 m0, s55, 0
    s_movk_i32 s62, 512
    buffer_load_dwordx4 v10, s[8:11], s62 offen lds
    s_sub_u32 s24, s68, 4096
    s_subb_u32 s25, s69, 0
    s_and_b32 s25, s25, 0xffff
    s_mov_b32 s26, 528384
    s_mov_b32 s27, 0x20000
    s_mov_b32 s40, s74
    s_and_b32 s41, s75, 0xffff
    s_mov_b32 s42, 3584
    s_mov_b32 s43, 0x20000
    s_sub_u32 s20, s76, 4096
    s_subb_u32 s21, s77, 0
    s_and_b32 s21, s21, 0xffff
    s_mov_b32 s22, 1839104
    s_mov_b32 s23, 0x20000
    s_mov_b32 s44, s78
    ds_read_b128 v[152:155], v4 offset:32768
    ds_read_b64_tr_b16 v[64:65], v8 offset:34816
    ds_read_b64_tr_b16 v[66:67], v8 offset:35328
    ds_read_b64_tr_b16 v[68:69], v8 offset:35840
    ds_read_b64_tr_b16 v[70:71], v8 offset:36352
    v_mfma_f32_32x32x16_bf16 v[96:111], v[48:51], v[144:147], v[96:111]
    v_mfma_f32_32x32x16_bf16 v[112:127], v[52:55], v[144:147], v[112:127]
    buffer_load_dwordx4 v11, s[8:11], s62 offen offset:1024 lds
    s_and_b32 s45, s79, 0xffff
    s_mov_b32 s46, 1024
    s_mov_b32 s47, 0x20000
    s_lshl_b32 s88, s49, 6
    v_lshl_add_u32 v34, v26, 1, s88
    buffer_load_ushort v28, v34, s[40:43], s58 offen
    s_xor_b32 s97, s49, s52
    s_and_b32 s97, s97, 1
    s_lshl_b32 s97, s97, 6
    buffer_load_ushort v29, v34, s[40:43], s57 offen
    s_lshl1_add_u32 s86, s52, s49
    s_lshl_b32 s86, s86, 17
    s_lshl_b32 s87, s53, 10
    s_add_u32 s86, s86, s87
    s_add_u32 s80, s86, 13631488
    ds_read_b128 v[156:159], v5 offset:32768
    ds_read_b64_tr_b16 v[72:73], v9 offset:34816
    ds_read_b64_tr_b16 v[74:75], v9 offset:35328
    ds_read_b64_tr_b16 v[76:77], v9 offset:35840
    ds_read_b64_tr_b16 v[78:79], v9 offset:36352
    s_waitcnt lgkmcnt(12)
    v_mfma_f32_32x32x16_bf16 v[96:111], v[56:59], v[148:151], v[96:111]
    s_waitcnt lgkmcnt(10)
    v_mfma_f32_32x32x16_bf16 v[112:127], v[60:63], v[148:151], v[112:127]
    s_mov_b32 s63, 786432
    buffer_load_dwordx4 v12, s[12:15], s63 offen offset:2048 lds
    s_mul_i32 s88, s53, 147456
    s_lshl_b32 s87, s49, 11
    s_add_u32 s87, s87, s88
    s_lshl_b32 s89, s58, 5
    s_add_u32 s82, s89, s87
    s_lshl_b32 s89, s57, 5
    s_add_u32 s81, s89, s87
    s_lshl_b32 s85, s51, 14
    s_lshl_b32 s87, s50, 8
    s_add_u32 s85, s85, s87
    s_add_u32 s85, s85, 15735808
    s_add_u32 s88, s58, 1024
    v_add_u32 v22, s88, v38
    s_lshr_b32 s86, s56, 7
    s_add_u32 s86, s86, 0
    s_waitcnt vmcnt(9)
    s_waitcnt lgkmcnt(0)
    s_barrier
    ds_read_b128 v[160:163], v80 offset:0
    ds_read_b64_tr_b16 v[48:49], v84 offset:2048
    ds_read_b64_tr_b16 v[50:51], v84 offset:2560
    ds_read_b64_tr_b16 v[52:53], v84 offset:3072
    ds_read_b64_tr_b16 v[54:55], v84 offset:3584
    v_mfma_f32_32x32x16_bf16 v[96:111], v[64:67], v[152:155], v[96:111]
    s_mov_b32 s63, 917504
    buffer_load_dwordx4 v13, s[16:19], s63 offen offset:3072 lds
    v_mfma_f32_32x32x16_bf16 v[112:127], v[68:71], v[152:155], v[112:127]
    s_add_u32 m0, s55, 32768
    s_movk_i32 s62, 640
    buffer_load_dwordx4 v10, s[8:11], s62 offen lds
    s_lshr_b32 s87, s86, 2
    s_lshl_b32 s87, s87, 14
    s_and_b32 s86, s86, 3
    s_lshl_b32 s86, s86, 11
    s_add_u32 s86, s86, s87
    s_add_u32 s56, s86, 15736832
    s_lshr_b32 s86, s57, 7
    s_add_u32 s86, s86, 24
    s_lshr_b32 s87, s86, 2
    s_lshl_b32 s87, s87, 14
    s_and_b32 s86, s86, 3
    s_lshl_b32 s86, s86, 11
    s_add_u32 s86, s86, s87
    s_add_u32 s57, s86, 15736832
    s_lshr_b32 s86, s58, 7
    ds_read_b128 v[164:167], v81 offset:0
    ds_read_b64_tr_b16 v[56:57], v85 offset:2048
    ds_read_b64_tr_b16 v[58:59], v85 offset:2560
    ds_read_b64_tr_b16 v[60:61], v85 offset:3072
    ds_read_b64_tr_b16 v[62:63], v85 offset:3584
    v_mfma_f32_32x32x16_bf16 v[96:111], v[72:75], v[156:159], v[96:111]
    v_mfma_f32_32x32x16_bf16 v[112:127], v[76:79], v[156:159], v[112:127]
    buffer_load_dwordx4 v11, s[8:11], s62 offen offset:1024 lds
    s_add_u32 s86, s86, 24
    s_lshr_b32 s87, s86, 2
    s_lshl_b32 s87, s87, 14
    s_and_b32 s86, s86, 3
    s_lshl_b32 s86, s86, 11
    s_add_u32 s86, s86, s87
    s_add_u32 s58, s86, 15736832
    s_lshr_b32 s86, s48, 1
    s_mov_b32 s98, s56
    s_cmp_eq_u32 s86, 1
    s_cselect_b32 s98, s57, s98
    s_cmp_eq_u32 s86, 2
    s_cselect_b32 s98, s58, s98
    s_cmp_eq_u32 s86, 3
    s_cselect_b32 s98, s58, s98
    s_and_b32 s86, s48, 1
    buffer_load_dword v249, v248, s[36:39], 0 offen offset:64 sc1
    ds_read_b128 v[168:171], v82 offset:0
    ds_read_b64_tr_b16 v[64:65], v86 offset:2048
    ds_read_b64_tr_b16 v[66:67], v86 offset:2560
    ds_read_b64_tr_b16 v[68:69], v86 offset:3072
    ds_read_b64_tr_b16 v[70:71], v86 offset:3584
    s_waitcnt lgkmcnt(12)
    v_mfma_f32_32x32x16_bf16 v[96:111], v[48:51], v[160:163], v[96:111]
    s_waitcnt lgkmcnt(10)
    v_mfma_f32_32x32x16_bf16 v[112:127], v[52:55], v[160:163], v[112:127]
    s_mov_b32 s63, 983040
    buffer_load_dwordx4 v12, s[12:15], s63 offen offset:2048 lds
    s_lshl_b32 s86, s86, 10
    s_add_u32 s98, s98, s86
    s_lshr_b32 s65, s2, 5
    s_lshl_b32 s64, s65, 3
    s_sub_u32 s66, s64, 8
    s_add_u32 s64, s64, s48
    s_sub_u32 s75, 8, s64
    s_cmp_gt_u32 s64, 8
    s_cselect_b32 s75, 0, s75
    s_lshl1_add_u32 s66, s48, s66
    s_lshl_b32 s66, s66, 10
    s_lshl_b32 s61, s99, 16
    s_add_u32 s66, s66, s61
    s_add_u32 s66, s66, 9437184
    s_lshl_b32 s67, s64, 10
    ds_read_b128 v[172:175], v83 offset:0
    ds_read_b64_tr_b16 v[72:73], v87 offset:2048
    ds_read_b64_tr_b16 v[74:75], v87 offset:2560
    ds_read_b64_tr_b16 v[76:77], v87 offset:3072
    ds_read_b64_tr_b16 v[78:79], v87 offset:3584
    s_waitcnt lgkmcnt(12)
    v_mfma_f32_32x32x16_bf16 v[96:111], v[56:59], v[164:167], v[96:111]
    s_waitcnt lgkmcnt(10)
    v_mfma_f32_32x32x16_bf16 v[112:127], v[60:63], v[164:167], v[112:127]
    s_mov_b32 s63, 1146880
    buffer_load_dwordx4 v13, s[16:19], s63 offen offset:3072 lds
    s_add_u32 s67, s67, s61
    s_add_u32 s67, s67, 13631488
    s_lshl1_add_u32 s70, s95, s49
    s_and_b32 s76, s48, 3
    s_mul_i32 s71, s70, 147456
    s_lshl_b32 s61, s76, 12
    s_add_u32 s71, s71, s61
    s_mov_b32 s72, 0
    s_lshl_b32 s77, s65, 15
    s_lshl_b32 s61, s99, 5
    s_add_u32 s77, s77, s61
    s_add_u32 s77, s77, 15729920
    s_mul_i32 s74, s64, 147456
    s_lshl_b32 s61, s99, 10
    s_add_u32 s74, s74, s61
    s_waitcnt vmcnt(11)
    s_waitcnt lgkmcnt(0)
    s_barrier
    ds_read_b128 v[176:179], v80 offset:32768
    ds_read_b64_tr_b16 v[48:49], v84 offset:34816
    ds_read_b64_tr_b16 v[50:51], v84 offset:35328
    ds_read_b64_tr_b16 v[52:53], v84 offset:35840
    ds_read_b64_tr_b16 v[54:55], v84 offset:36352
    v_mfma_f32_32x32x16_bf16 v[96:111], v[64:67], v[168:171], v[96:111]
    v_mfma_f32_32x32x16_bf16 v[112:127], v[68:71], v[168:171], v[112:127]
    s_add_u32 m0, s55, 65536
    s_movk_i32 s62, 768
    buffer_load_dwordx4 v10, s[8:11], s62 offen lds
    s_add_u32 s74, s74, 114688
    s_mov_b32 s40, 0x41065410
    s_mov_b32 s41, 5
    s_and_b32 s61, s95, 3
    s_or_b32 s73, s96, 4
    s_lshl1_add_u32 s73, s61, s73
    s_mul_i32 s61, s73, 52
    s_lshr_b32 s61, s61, 8
    s_mul_i32 s61, s61, 5
    s_sub_u32 s61, s73, s61
    s_add_u32 s73, s96, s95
    s_and_b32 s73, s73, 1
    s_lshl3_add_u32 s73, s73, s61
    ds_read_b128 v[180:183], v81 offset:32768
    ds_read_b64_tr_b16 v[56:57], v85 offset:34816
    ds_read_b64_tr_b16 v[58:59], v85 offset:35328
    ds_read_b64_tr_b16 v[60:61], v85 offset:35840
    ds_read_b64_tr_b16 v[62:63], v85 offset:36352
    v_mfma_f32_32x32x16_bf16 v[96:111], v[72:75], v[172:175], v[96:111]
    v_mfma_f32_32x32x16_bf16 v[112:127], v[76:79], v[172:175], v[112:127]
    buffer_load_dwordx4 v11, s[8:11], s62 offen offset:1024 lds
    s_waitcnt vmcnt(4)
    v_cmp_ne_u32 vcc, 1, v249
    s_nop 0
    s_cmp_eq_u64 vcc, 0
    s_cbranch_scc1 ARMOK_17
    s_mov_b32 s94, 0
ARMLP_18:
    s_nop 4
    s_sleep 2
    buffer_load_dword v249, v248, s[36:39], 0 offen offset:64 sc1
    s_waitcnt vmcnt(0)
    s_add_u32 s94, s94, 1
    s_cmp_gt_u32 s94, 0x40000
    s_cbranch_scc1 ARMOK_17
    v_cmp_ne_u32 vcc, 1, v249
    s_nop 0
    s_cmp_eq_u64 vcc, 0
    s_cbranch_scc0 ARMLP_18
    s_nop 1
ARMOK_17:
    buffer_store_dwordx2 v[240:241], v252, s[28:31], 0 offen sc1
    buffer_store_dwordx2 v[244:245], v255, s[28:31], 0 offen sc1
    ds_read_b128 v[184:187], v82 offset:32768
    ds_read_b64_tr_b16 v[64:65], v86 offset:34816
    ds_read_b64_tr_b16 v[66:67], v86 offset:35328
    ds_read_b64_tr_b16 v[68:69], v86 offset:35840
    ds_read_b64_tr_b16 v[70:71], v86 offset:36352
    s_waitcnt lgkmcnt(12)
    v_mfma_f32_32x32x16_bf16 v[96:111], v[48:51], v[176:179], v[96:111]
    s_waitcnt lgkmcnt(10)
    v_mfma_f32_32x32x16_bf16 v[112:127], v[52:55], v[176:179], v[112:127]
    s_mov_b32 s63, 1179648
    buffer_load_dwordx4 v12, s[12:15], s63 offen offset:2048 lds
    ds_read_b128 v[188:191], v83 offset:32768
    ds_read_b64_tr_b16 v[72:73], v87 offset:34816
    ds_read_b64_tr_b16 v[74:75], v87 offset:35328
    ds_read_b64_tr_b16 v[76:77], v87 offset:35840
    ds_read_b64_tr_b16 v[78:79], v87 offset:36352
    s_waitcnt lgkmcnt(12)
    v_mfma_f32_32x32x16_bf16 v[96:111], v[56:59], v[180:183], v[96:111]
    s_waitcnt lgkmcnt(10)
    v_mfma_f32_32x32x16_bf16 v[112:127], v[60:63], v[180:183], v[112:127]
    s_mov_b32 s63, 1376256
    buffer_load_dwordx4 v13, s[16:19], s63 offen offset:3072 lds
    s_cmp_gt_u32 s48, 1
    s_cbranch_scc1 NOWARM_19
    s_lshl_b32 s86, s48, 8
    s_add_u32 s86, s86, s2
    s_lshl_b32 s86, s86, 13
    s_add_u32 s86, s86, 4096
    s_sub_u32 s87, s86, 1835008
    s_cmp_lt_u32 s86, 1839104
    s_cselect_b32 s87, 0x40000000, s87
    v_lshlrev_b32 v246, 7, v0
    buffer_load_dword v247, v246, s[20:23], s86 offen
    buffer_load_dword v243, v246, s[24:27], s87 offen
NOWARM_19:
    s_waitcnt lgkmcnt(0)
    s_barrier
    ds_read_b128 v[192:195], v2 offset:0
    ds_read_b64_tr_b16 v[48:49], v6 offset:2048
    ds_read_b64_tr_b16 v[50:51], v6 offset:2560
    ds_read_b64_tr_b16 v[52:53], v6 offset:3072
    ds_read_b64_tr_b16 v[54:55], v6 offset:3584
    v_mfma_f32_32x32x16_bf16 v[96:111], v[64:67], v[184:187], v[96:111]
    v_mfma_f32_32x32x16_bf16 v[112:127], v[68:71], v[184:187], v[112:127]
    s_add_u32 m0, s55, 98304
    s_movk_i32 s62, 896
    buffer_load_dwordx4 v10, s[8:11], s62 offen lds
    ds_read_b128 v[196:199], v3 offset:0
    ds_read_b64_tr_b16 v[56:57], v7 offset:2048
    ds_read_b64_tr_b16 v[58:59], v7 offset:2560
    ds_read_b64_tr_b16 v[60:61], v7 offset:3072
    ds_read_b64_tr_b16 v[62:63], v7 offset:3584
    v_mfma_f32_32x32x16_bf16 v[96:111], v[72:75], v[188:191], v[96:111]
    v_mfma_f32_32x32x16_bf16 v[112:127], v[76:79], v[188:191], v[112:127]
    buffer_load_dwordx4 v11, s[8:11], s62 offen offset:1024 lds
    ds_read_b128 v[200:203], v4 offset:0
    ds_read_b64_tr_b16 v[64:65], v8 offset:2048
    ds_read_b64_tr_b16 v[66:67], v8 offset:2560
    ds_read_b64_tr_b16 v[68:69], v8 offset:3072
    ds_read_b64_tr_b16 v[70:71], v8 offset:3584
    s_waitcnt lgkmcnt(12)
    v_mfma_f32_32x32x16_bf16 v[96:111], v[48:51], v[192:195], v[96:111]
    s_waitcnt lgkmcnt(10)
    v_mfma_f32_32x32x16_bf16 v[112:127], v[52:55], v[192:195], v[112:127]
    s_mov_b32 s63, 1376256
    buffer_load_dwordx4 v12, s[12:15], s63 offen offset:2048 lds
    ds_read_b128 v[204:207], v5 offset:0
    ds_read_b64_tr_b16 v[72:73], v9 offset:2048
    ds_read_b64_tr_b16 v[74:75], v9 offset:2560
    ds_read_b64_tr_b16 v[76:77], v9 offset:3072
    ds_read_b64_tr_b16 v[78:79], v9 offset:3584
    s_waitcnt lgkmcnt(12)
    v_mfma_f32_32x32x16_bf16 v[96:111], v[56:59], v[196:199], v[96:111]
    s_waitcnt lgkmcnt(10)
    v_mfma_f32_32x32x16_bf16 v[112:127], v[60:63], v[196:199], v[112:127]
    s_mov_b32 s63, 1605632
    buffer_load_dwordx4 v13, s[16:19], s63 offen offset:3072 lds
    s_waitcnt vmcnt(10)
    s_waitcnt lgkmcnt(0)
    s_barrier
    ds_read_b128 v[208:211], v2 offset:32768
    ds_read_b64_tr_b16 v[48:49], v6 offset:34816
    ds_read_b64_tr_b16 v[50:51], v6 offset:35328
    ds_read_b64_tr_b16 v[52:53], v6 offset:35840
    ds_read_b64_tr_b16 v[54:55], v6 offset:36352
    v_mfma_f32_32x32x16_bf16 v[96:111], v[64:67], v[200:203], v[96:111]
    v_mfma_f32_32x32x16_bf16 v[112:127], v[68:71], v[200:203], v[112:127]
    s_add_u32 m0, s55, 0
    s_mov_b32 s63, 3072
    buffer_load_dwordx4 v22, s[16:19], s63 offen offset:0 lds
    ds_read_b128 v[212:215], v3 offset:32768
    ds_read_b64_tr_b16 v[56:57], v7 offset:34816
    ds_read_b64_tr_b16 v[58:59], v7 offset:35328
    ds_read_b64_tr_b16 v[60:61], v7 offset:35840
    ds_read_b64_tr_b16 v[62:63], v7 offset:36352
    v_mfma_f32_32x32x16_bf16 v[96:111], v[72:75], v[204:207], v[96:111]
    v_mfma_f32_32x32x16_bf16 v[112:127], v[76:79], v[204:207], v[112:127]
    s_mov_b32 s63, 231424
    buffer_load_dwordx4 v22, s[16:19], s63 offen offset:1024 lds
    ds_read_b128 v[216:219], v4 offset:32768
    ds_read_b64_tr_b16 v[64:65], v8 offset:34816
    ds_read_b64_tr_b16 v[66:67], v8 offset:35328
    ds_read_b64_tr_b16 v[68:69], v8 offset:35840
    ds_read_b64_tr_b16 v[70:71], v8 offset:36352
    s_waitcnt lgkmcnt(12)
    v_mfma_f32_32x32x16_bf16 v[96:111], v[48:51], v[208:211], v[96:111]
    s_waitcnt lgkmcnt(10)
    v_mfma_f32_32x32x16_bf16 v[112:127], v[52:55], v[208:211], v[112:127]
    s_mov_b32 s63, 459776
    buffer_load_dwordx4 v22, s[16:19], s63 offen offset:2048 lds
    ds_read_b128 v[220:223], v5 offset:32768
    ds_read_b64_tr_b16 v[72:73], v9 offset:34816
    ds_read_b64_tr_b16 v[74:75], v9 offset:35328
    ds_read_b64_tr_b16 v[76:77], v9 offset:35840
    ds_read_b64_tr_b16 v[78:79], v9 offset:36352
    s_waitcnt lgkmcnt(12)
    v_mfma_f32_32x32x16_bf16 v[96:111], v[56:59], v[212:215], v[96:111]
    s_waitcnt lgkmcnt(10)
    v_mfma_f32_32x32x16_bf16 v[112:127], v[60:63], v[212:215], v[112:127]
    s_mov_b32 s63, 688128
    buffer_load_dwordx4 v22, s[16:19], s63 offen offset:3072 lds
    s_lshr_b32 s86, s55, 2
    s_add_u32 m0, s86, 131072
    s_nop 0
    buffer_load_dwordx4 v15, s[28:31], s98 offen sc1 lds
    s_cmp_lg_u32 s48, 0
    s_cbranch_scc1 NOROWG_20
    s_lshl_b32 s86, s51, 14
    s_add_u32 s86, s86, 15735808
    s_mov_b32 m0, 139264
    s_nop 0
    buffer_load_dwordx4 v15, s[28:31], s86 offen sc1 lds
    s_waitcnt vmcnt(63)
NOROWG_20:
    s_waitcnt vmcnt(9)
    s_waitcnt lgkmcnt(0)
    s_barrier
    ds_read_b128 v[224:227], v80 offset:0
    ds_read_b64_tr_b16 v[48:49], v84 offset:2048
    ds_read_b64_tr_b16 v[50:51], v84 offset:2560
    ds_read_b64_tr_b16 v[52:53], v84 offset:3072
    ds_read_b64_tr_b16 v[54:55], v84 offset:3584
    v_mfma_f32_32x32x16_bf16 v[96:111], v[64:67], v[216:219], v[96:111]
    v_mfma_f32_32x32x16_bf16 v[112:127], v[68:71], v[216:219], v[112:127]
    s_add_u32 m0, s55, 32768
    s_mov_b32 s63, 920576
    buffer_load_dwordx4 v22, s[16:19], s63 offen offset:0 lds
    ds_read_b128 v[228:231], v81 offset:0
    ds_read_b64_tr_b16 v[56:57], v85 offset:2048
    ds_read_b64_tr_b16 v[58:59], v85 offset:2560
    ds_read_b64_tr_b16 v[60:61], v85 offset:3072
    ds_read_b64_tr_b16 v[62:63], v85 offset:3584
    v_mfma_f32_32x32x16_bf16 v[96:111], v[72:75], v[220:223], v[96:111]
    v_mfma_f32_32x32x16_bf16 v[112:127], v[76:79], v[220:223], v[112:127]
    s_mov_b32 s63, 1148928
    buffer_load_dwordx4 v22, s[16:19], s63 offen offset:1024 lds
    ds_read_b128 v[232:235], v82 offset:0
    ds_read_b64_tr_b16 v[64:65], v86 offset:2048
    ds_read_b64_tr_b16 v[66:67], v86 offset:2560
    ds_read_b64_tr_b16 v[68:69], v86 offset:3072
    ds_read_b64_tr_b16 v[70:71], v86 offset:3584
    s_waitcnt lgkmcnt(12)
    v_mfma_f32_32x32x16_bf16 v[96:111], v[48:51], v[224:227], v[96:111]
    s_waitcnt lgkmcnt(10)
    v_mfma_f32_32x32x16_bf16 v[112:127], v[52:55], v[224:227], v[112:127]
    s_mov_b32 s63, 1377280
    buffer_load_dwordx4 v22, s[16:19], s63 offen offset:2048 lds
    ds_read_b128 v[236:239], v83 offset:0
    ds_read_b64_tr_b16 v[72:73], v87 offset:2048
    ds_read_b64_tr_b16 v[74:75], v87 offset:2560
    ds_read_b64_tr_b16 v[76:77], v87 offset:3072
    ds_read_b64_tr_b16 v[78:79], v87 offset:3584
    s_waitcnt lgkmcnt(12)
    v_mfma_f32_32x32x16_bf16 v[96:111], v[56:59], v[228:231], v[96:111]
    s_waitcnt lgkmcnt(10)
    v_mfma_f32_32x32x16_bf16 v[112:127], v[60:63], v[228:231], v[112:127]
    s_mov_b32 s63, 1605632
    buffer_load_dwordx4 v22, s[16:19], s63 offen offset:3072 lds
    s_waitcnt vmcnt(4)
    s_waitcnt lgkmcnt(0)
    s_barrier
    ds_read_b128 v[240:243], v80 offset:32768
    ds_read_b64_tr_b16 v[48:49], v84 offset:34816
    ds_read_b64_tr_b16 v[50:51], v84 offset:35328
    ds_read_b64_tr_b16 v[52:53], v84 offset:35840
    ds_read_b64_tr_b16 v[54:55], v84 offset:36352
    v_mfma_f32_32x32x16_bf16 v[96:111], v[64:67], v[232:235], v[96:111]
    v_mfma_f32_32x32x16_bf16 v[112:127], v[68:71], v[232:235], v[112:127]
    s_and_b32 s60, s73, 7
    s_add_u32 s60, s60, 0
    s_lshl_b32 s60, s60, 2
    s_lshr_b64 s[60:61], s[40:41], s60
    s_and_b32 s60, s60, 15
    s_add_u32 m0, s55, 65536
    s_lshl_b32 s100, s60, 18
    buffer_load_dwordx4 v1, s[20:23], s100 offen offset:0 lds
    s_lshl_b32 s86, s50, 8
    s_add_u32 s86, s86, 139264
    v_lshl_add_u32 v20, v26, 3, s86
    v_add_u32 v21, 131072, v30
    ds_read_b64 v[16:17], v20
    ds_read_b128 v[32:35], v21
    ds_read_b128 v[36:39], v21 offset:16
    ds_read_b128 v[40:43], v21 offset:2048
    ds_read_b128 v[44:47], v21 offset:2064
    ds_read_b128 v[88:91], v21 offset:4096
    ds_read_b128 v[92:95], v21 offset:4112
    ds_read_b128 v[244:247], v81 offset:32768
    ds_read_b64_tr_b16 v[56:57], v85 offset:34816
    ds_read_b64_tr_b16 v[58:59], v85 offset:35328
    ds_read_b64_tr_b16 v[60:61], v85 offset:35840
    ds_read_b64_tr_b16 v[62:63], v85 offset:36352
    v_mfma_f32_32x32x16_bf16 v[96:111], v[72:75], v[236:239], v[96:111]
    v_mfma_f32_32x32x16_bf16 v[112:127], v[76:79], v[236:239], v[112:127]
    s_add_u32 s100, s100, 64512
    buffer_load_dwordx4 v1, s[20:23], s100 offen offset:1024 lds
    s_waitcnt lgkmcnt(10)
    v_and_b32 v20, v17, v33
    s_waitcnt lgkmcnt(9)
    v_and_b32 v21, v35, v37
    v_and_b32 v20, v20, v39
    s_waitcnt lgkmcnt(8)
    v_and_b32 v21, v21, v41
    v_and_b32 v20, v20, v43
    s_waitcnt lgkmcnt(7)
    v_and_b32 v21, v21, v45
    v_and_b32 v20, v20, v47
    s_waitcnt lgkmcnt(6)
    v_and_b32 v21, v21, v89
    v_and_b32 v20, v20, v91
    s_waitcnt lgkmcnt(5)
    v_and_b32 v21, v21, v93
    v_and_b32 v20, v20, v95
    v_and_b32 v20, v20, v21
    v_cmp_ne_u32 vcc, 1, v20
    s_nop 0
    s_cmp_eq_u64 vcc, 0
    s_cbranch_scc1 GROK_21
    s_mov_b32 s94, 0
GRLP_22:
    s_nop 0
    s_sleep 2
    v_lshlrev_b32 v20, 3, v26
    buffer_load_dwordx2 v[16:17], v20, s[28:31], s85 offen sc1
    buffer_load_dwordx4 v[32:35], v30, s[28:31], s56 offen sc1
    buffer_load_dwordx4 v[36:39], v30, s[28:31], s56 offen offset:16 sc1
    buffer_load_dwordx4 v[40:43], v30, s[28:31], s57 offen sc1
    buffer_load_dwordx4 v[44:47], v30, s[28:31], s57 offen offset:16 sc1
    buffer_load_dwordx4 v[88:91], v30, s[28:31], s58 offen sc1
    buffer_load_dwordx4 v[92:95], v30, s[28:31], s58 offen offset:16 sc1
    s_waitcnt vmcnt(0)
    s_add_u32 s94, s94, 1
    s_cmp_gt_u32 s94, 0x40000
    s_cbranch_scc1 GROK_21
    v_and_b32 v20, v17, v33
    v_and_b32 v21, v35, v37
    v_and_b32 v20, v20, v39
    v_and_b32 v21, v21, v41
    v_and_b32 v20, v20, v43
    v_and_b32 v21, v21, v45
    v_and_b32 v20, v20, v47
    v_and_b32 v21, v21, v89
    v_and_b32 v20, v20, v91
    v_and_b32 v21, v21, v93
    v_and_b32 v20, v20, v95
    v_and_b32 v20, v20, v21
    v_cmp_ne_u32 vcc, 1, v20
    s_nop 0
    s_cmp_eq_u64 vcc, 0
    s_cbranch_scc0 GRLP_22
    s_nop 1
GROK_21:
    v_add_f32 v32, v32, v34
    v_add_f32 v36, v36, v38
    v_add_f32 v40, v40, v42
    v_add_f32 v44, v44, v46
    v_add_f32 v88, v88, v90
    v_add_f32 v92, v92, v94
    v_add_f32 v32, v32, v36
    v_add_f32 v33, v40, v44
    v_add_f32 v34, v88, v92
    v_and_b32 v2, 0xffff0000, v16
    v_rcp_f32 v25, v2
    v_cmp_eq_u32 vcc, 0, v27
    s_nop 1
    v_cndmask_b32 v17, 0, v16, vcc
    v_and_b32 v16, 0xffff, v17
    v_lshl_or_b32 v16, v16, 16, v16
    v_mov_b32 v11, v23
    v_mov_b32 v22, 0
    v_mov_b32 v23, 0
    v_lshlrev_b32 v28, 16, v28
    v_lshlrev_b32 v29, 16, v29
    ds_read_b128 v[248:251], v82 offset:32768
    ds_read_b64_tr_b16 v[64:65], v86 offset:34816
    ds_read_b64_tr_b16 v[66:67], v86 offset:35328
    ds_read_b64_tr_b16 v[68:69], v86 offset:35840
    ds_read_b64_tr_b16 v[70:71], v86 offset:36352
    v_mfma_f32_32x32x16_bf16 v[96:111], v[48:51], v[240:243], v[96:111]
    v_mfma_f32_32x32x16_bf16 v[112:127], v[52:55], v[240:243], v[112:127]
    s_add_u32 s100, s100, 64512
    buffer_load_dwordx4 v1, s[20:23], s100 offen offset:2048 lds
    v_cvt_pk_bf16_f32 v46, v32, v32
    v_lshlrev_b32 v46, 16, v46
    v_sub_f32 v46, v32, v46
    v_cvt_pk_bf16_f32 v20, v32, v46
    v_and_b32 v47, 0xffff0000, v20
    v_sub_f32 v46, v46, v47
    v_cvt_pk_bf16_f32 v21, v46, 0
    s_nop 1
    v_mfma_f32_32x32x16_bf16 v[96:111], v[20:23], v[16:19], v[96:111]
    ds_read_b128 v[252:255], v83 offset:32768
    ds_read_b64_tr_b16 v[72:73], v87 offset:34816
    ds_read_b64_tr_b16 v[74:75], v87 offset:35328
    ds_read_b64_tr_b16 v[76:77], v87 offset:35840
    ds_read_b64_tr_b16 v[78:79], v87 offset:36352
    s_waitcnt lgkmcnt(12)
    v_mfma_f32_32x32x16_bf16 v[96:111], v[56:59], v[244:247], v[96:111]
    s_waitcnt lgkmcnt(10)
    v_mfma_f32_32x32x16_bf16 v[112:127], v[60:63], v[244:247], v[112:127]
    s_add_u32 s100, s100, 64512
    buffer_load_dwordx4 v1, s[20:23], s100 offen offset:3072 lds
    v_mul_f32 v10, v25, v25
    v_mul_f32 v24, 3222493025, v25
    v_mul_f32 v10, s93, v10
    v_mul_f32 v10, v10, v25
    v_lshlrev_b32 v3, 26, v0
    v_mov_b32 v4, 1
    v_cvt_pk_bf16_f32 v46, v33, v33
    v_lshlrev_b32 v46, 16, v46
    v_sub_f32 v46, v33, v46
    v_cvt_pk_bf16_f32 v20, v33, v46
    v_and_b32 v47, 0xffff0000, v20
    v_sub_f32 v46, v46, v47
    v_cvt_pk_bf16_f32 v21, v46, v29
    s_nop 1
    v_mfma_f32_32x32x16_bf16 v[112:127], v[20:23], v[16:19], v[112:127]
    s_waitcnt lgkmcnt(0)
    s_barrier
    ds_read_b64_tr_b16 v[48:49], v6 offset:0
    ds_read_b64_tr_b16 v[50:51], v6 offset:512
    ds_read_b64_tr_b16 v[52:53], v7 offset:0
    ds_read_b64_tr_b16 v[54:55], v7 offset:512
    v_mfma_f32_32x32x16_bf16 v[96:111], v[64:67], v[248:251], v[96:111]
    v_mfma_f32_32x32x16_bf16 v[112:127], v[68:71], v[248:251], v[112:127]
    s_bfe_u32 s60, s73, 0x10003
    s_xor_b32 s60, s60, 0
    s_add_u32 s60, s60, 2
    s_add_u32 m0, s55, 98304
    s_lshl_b32 s100, s60, 18
    buffer_load_dwordx4 v1, s[20:23], s100 offen offset:0 lds
    v_cvt_pk_bf16_f32 v46, v34, v34
    v_lshlrev_b32 v46, 16, v46
    v_sub_f32 v46, v34, v46
    v_cvt_pk_bf16_f32 v20, v34, v46
    v_and_b32 v47, 0xffff0000, v20
    v_sub_f32 v46, v46, v47
    v_cvt_pk_bf16_f32 v21, v46, v28
    s_nop 1
    v_mfma_f32_32x32x16_bf16 v[80:95], v[20:23], v[16:19], 0
    ds_read_b64_tr_b16 v[56:57], v8 offset:0
    ds_read_b64_tr_b16 v[58:59], v8 offset:512
    v_mfma_f32_32x32x16_bf16 v[96:111], v[72:75], v[252:255], v[96:111]
    v_mfma_f32_32x32x16_bf16 v[112:127], v[76:79], v[252:255], v[112:127]
    s_add_u32 s100, s100, 64512
    buffer_load_dwordx4 v1, s[20:23], s100 offen offset:1024 lds
    v_mul_f32 v32, 1052289595, v25
    ds_read_b64_tr_b16 v[60:61], v9 offset:0
    ds_read_b64_tr_b16 v[62:63], v9 offset:512
    s_waitcnt lgkmcnt(6)
    v_mfma_f32_32x32x16_bf16 v[80:95], v[48:51], v[128:131], v[80:95]
    s_add_u32 s100, s100, 64512
    buffer_load_dwordx4 v1, s[20:23], s100 offen offset:2048 lds
    ds_read_b64_tr_b16 v[48:49], v6 offset:1024
    ds_read_b64_tr_b16 v[50:51], v6 offset:1536
    s_waitcnt lgkmcnt(6)
    v_mfma_f32_32x32x16_bf16 v[80:95], v[52:55], v[132:135], v[80:95]
    v_mul_f32 v96, v32, v96
    v_mul_f32 v97, v32, v97
    v_mul_f32 v98, v32, v98
    v_mul_f32 v99, v32, v99
    v_mul_f32 v100, v32, v100
    v_mul_f32 v101, v32, v101
    s_add_u32 s100, s100, 64512
    buffer_load_dwordx4 v1, s[20:23], s100 offen offset:3072 lds
    ds_read_b64_tr_b16 v[52:53], v7 offset:1024
    ds_read_b64_tr_b16 v[54:55], v7 offset:1536
    s_waitcnt lgkmcnt(6)
    v_mfma_f32_32x32x16_bf16 v[80:95], v[56:59], v[136:139], v[80:95]
    v_mul_f32 v102, v32, v102
    v_mul_f32 v103, v32, v103
    v_cvt_pk_bf16_f32 v96, v96, v97
    v_cvt_pk_bf16_f32 v97, v98, v99
    v_cvt_pk_bf16_f32 v98, v100, v101
    v_cvt_pk_bf16_f32 v99, v102, v103
    ds_read_b64_tr_b16 v[56:57], v8 offset:1024
    ds_read_b64_tr_b16 v[58:59], v8 offset:1536
    s_waitcnt lgkmcnt(6)
    v_mfma_f32_32x32x16_bf16 v[80:95], v[60:63], v[140:143], v[80:95]
    buffer_store_dwordx4 v[96:99], v15, s[28:31], s80 offen sc1
    v_mul_f32 v104, v32, v104
    v_mul_f32 v105, v32, v105
    v_mul_f32 v106, v32, v106
    v_mul_f32 v107, v32, v107
    ds_read_b64_tr_b16 v[60:61], v9 offset:1024
    ds_read_b64_tr_b16 v[62:63], v9 offset:1536
    s_waitcnt lgkmcnt(6)
    v_mfma_f32_32x32x16_bf16 v[80:95], v[48:51], v[144:147], v[80:95]
    v_mul_f32 v108, v32, v108
    v_mul_f32 v109, v32, v109
    v_mul_f32 v110, v32, v110
    v_mul_f32 v111, v32, v111
    v_cvt_pk_bf16_f32 v104, v104, v105
    v_cvt_pk_bf16_f32 v105, v106, v107
    ds_read_b64_tr_b16 v[48:49], v6 offset:2048
    ds_read_b64_tr_b16 v[50:51], v6 offset:2560
    s_waitcnt lgkmcnt(6)
    v_mfma_f32_32x32x16_bf16 v[80:95], v[52:55], v[148:151], v[80:95]
    v_cvt_pk_bf16_f32 v106, v108, v109
    v_cvt_pk_bf16_f32 v107, v110, v111
    s_add_u32 s80, s80, 65536
    buffer_store_dwordx4 v[104:107], v15, s[28:31], s80 offen sc1
    v_mul_f32 v64, v112, v112
    ds_read_b64_tr_b16 v[52:53], v7 offset:2048
    ds_read_b64_tr_b16 v[54:55], v7 offset:2560
    s_waitcnt lgkmcnt(6)
    v_mfma_f32_32x32x16_bf16 v[80:95], v[56:59], v[152:155], v[80:95]
    v_mul_f32 v65, v113, v113
    v_mul_f32 v66, v114, v114
    v_mul_f32 v67, v115, v115
    v_mul_f32 v68, v116, v116
    v_mul_f32 v69, v117, v117
    v_mul_f32 v70, v118, v118
    ds_read_b64_tr_b16 v[56:57], v8 offset:2048
    ds_read_b64_tr_b16 v[58:59], v8 offset:2560
    s_waitcnt lgkmcnt(6)
    v_mfma_f32_32x32x16_bf16 v[80:95], v[60:63], v[156:159], v[80:95]
    v_mul_f32 v71, v119, v119
    v_fma_f32 v64, v64, v10, v24
    v_fma_f32 v65, v65, v10, v24
    v_fma_f32 v66, v66, v10, v24
    v_fma_f32 v67, v67, v10, v24
    v_fma_f32 v68, v68, v10, v24
    ds_read_b64_tr_b16 v[60:61], v9 offset:2048
    ds_read_b64_tr_b16 v[62:63], v9 offset:2560
    s_waitcnt lgkmcnt(6)
    v_mfma_f32_32x32x16_bf16 v[80:95], v[48:51], v[160:163], v[80:95]
    v_fma_f32 v69, v69, v10, v24
    v_fma_f32 v70, v70, v10, v24
    v_fma_f32 v71, v71, v10, v24
    v_mul_f32 v64, v64, v112
    v_mul_f32 v65, v65, v113
    ds_read_b64_tr_b16 v[48:49], v6 offset:3072
    ds_read_b64_tr_b16 v[50:51], v6 offset:3584
    s_waitcnt lgkmcnt(6)
    v_mfma_f32_32x32x16_bf16 v[80:95], v[52:55], v[164:167], v[80:95]
    v_mul_f32 v66, v66, v114
    v_mul_f32 v67, v67, v115
    v_mul_f32 v68, v68, v116
    v_mul_f32 v69, v69, v117
    v_mul_f32 v70, v70, v118
    v_mul_f32 v71, v71, v119
    ds_read_b64_tr_b16 v[52:53], v7 offset:3072
    ds_read_b64_tr_b16 v[54:55], v7 offset:3584
    s_waitcnt lgkmcnt(6)
    v_mfma_f32_32x32x16_bf16 v[80:95], v[56:59], v[168:171], v[80:95]
    v_exp_f32 v64, v64
    v_exp_f32 v65, v65
    v_exp_f32 v66, v66
    v_exp_f32 v67, v67
    v_exp_f32 v68, v68
    ds_read_b64_tr_b16 v[56:57], v8 offset:3072
    ds_read_b64_tr_b16 v[58:59], v8 offset:3584
    s_waitcnt lgkmcnt(6)
    v_mfma_f32_32x32x16_bf16 v[80:95], v[60:63], v[172:175], v[80:95]
    v_exp_f32 v69, v69
    v_exp_f32 v70, v70
    v_exp_f32 v71, v71
    v_fma_f32 v64, v64, v2, v2
    v_fma_f32 v65, v65, v2, v2
    v_fma_f32 v66, v66, v2, v2
    ds_read_b64_tr_b16 v[60:61], v9 offset:3072
    ds_read_b64_tr_b16 v[62:63], v9 offset:3584
    s_waitcnt lgkmcnt(6)
    v_mfma_f32_32x32x16_bf16 v[80:95], v[48:51], v[176:179], v[80:95]
    v_fma_f32 v67, v67, v2, v2
    v_fma_f32 v68, v68, v2, v2
    v_fma_f32 v69, v69, v2, v2
    v_fma_f32 v70, v70, v2, v2
    v_fma_f32 v71, v71, v2, v2
    s_waitcnt vmcnt(0)
    s_waitcnt lgkmcnt(0)
    s_barrier
    s_nop 3
    s_cmp_lg_u32 s48, 0
    s_cbranch_scc1 W0_23
    buffer_store_dword v4, v3, s[28:31], s92 offen offset:256 sc1
W0_23:
    ds_read_b64_tr_b16 v[48:49], v6 offset:32768
    ds_read_b64_tr_b16 v[50:51], v6 offset:33280
    v_mfma_f32_32x32x16_bf16 v[80:95], v[52:55], v[180:183], v[80:95]
    v_rcp_f32 v64, v64
    v_rcp_f32 v65, v65
    v_rcp_f32 v66, v66
    v_rcp_f32 v67, v67
    v_rcp_f32 v68, v68
    v_rcp_f32 v69, v69
    v_rcp_f32 v70, v70
    s_bfe_u32 s60, s73, 0x10003
    s_xor_b32 s60, s60, 1
    s_add_u32 s60, s60, 2
    s_add_u32 m0, s55, 0
    s_lshl_b32 s100, s60, 18
    buffer_load_dwordx4 v1, s[20:23], s100 offen offset:0 lds
    ds_read_b64_tr_b16 v[52:53], v7 offset:32768
    ds_read_b64_tr_b16 v[54:55], v7 offset:33280
    v_mfma_f32_32x32x16_bf16 v[80:95], v[56:59], v[184:187], v[80:95]
    v_rcp_f32 v71, v71
    v_mul_f32 v112, v112, v64
    v_mul_f32 v113, v113, v65
    v_mul_f32 v114, v114, v66
    v_mul_f32 v115, v115, v67
    v_mul_f32 v116, v116, v68
    ds_read_b64_tr_b16 v[56:57], v8 offset:32768
    ds_read_b64_tr_b16 v[58:59], v8 offset:33280
    v_mfma_f32_32x32x16_bf16 v[80:95], v[60:63], v[188:191], v[80:95]
    v_mul_f32 v117, v117, v69
    v_mul_f32 v118, v118, v70
    v_mul_f32 v119, v119, v71
    v_cvt_pk_bf16_f32 v112, v112, v113
    v_cvt_pk_bf16_f32 v113, v114, v115
    v_cvt_pk_bf16_f32 v114, v116, v117
    s_add_u32 s100, s100, 64512
    buffer_load_dwordx4 v1, s[20:23], s100 offen offset:1024 lds
    ds_read_b64_tr_b16 v[60:61], v9 offset:32768
    ds_read_b64_tr_b16 v[62:63], v9 offset:33280
    s_waitcnt lgkmcnt(6)
    v_mfma_f32_32x32x16_bf16 v[80:95], v[48:51], v[192:195], v[80:95]
    v_cvt_pk_bf16_f32 v115, v118, v119
    buffer_store_dwordx4 v[112:115], v15, s[28:31], s81 offen offset:0 sc1
    v_mul_f32 v64, v120, v120
    v_mul_f32 v65, v121, v121
    v_mul_f32 v66, v122, v122
    v_mul_f32 v67, v123, v123
    ds_read_b64_tr_b16 v[48:49], v6 offset:33792
    ds_read_b64_tr_b16 v[50:51], v6 offset:34304
    s_waitcnt lgkmcnt(6)
    v_mfma_f32_32x32x16_bf16 v[80:95], v[52:55], v[196:199], v[80:95]
    v_mul_f32 v68, v124, v124
    v_mul_f32 v69, v125, v125
    v_mul_f32 v70, v126, v126
    v_mul_f32 v71, v127, v127
    v_fma_f32 v64, v64, v10, v24
    v_fma_f32 v65, v65, v10, v24
    s_add_u32 s100, s100, 64512
    buffer_load_dwordx4 v1, s[20:23], s100 offen offset:2048 lds
    ds_read_b64_tr_b16 v[52:53], v7 offset:33792
    ds_read_b64_tr_b16 v[54:55], v7 offset:34304
    s_waitcnt lgkmcnt(6)
    v_mfma_f32_32x32x16_bf16 v[80:95], v[56:59], v[200:203], v[80:95]
    v_fma_f32 v66, v66, v10, v24
    v_fma_f32 v67, v67, v10, v24
    v_fma_f32 v68, v68, v10, v24
    v_fma_f32 v69, v69, v10, v24
    v_fma_f32 v70, v70, v10, v24
    v_fma_f32 v71, v71, v10, v24
    ds_read_b64_tr_b16 v[56:57], v8 offset:33792
    ds_read_b64_tr_b16 v[58:59], v8 offset:34304
    s_waitcnt lgkmcnt(6)
    v_mfma_f32_32x32x16_bf16 v[80:95], v[60:63], v[204:207], v[80:95]
    v_mul_f32 v64, v64, v120
    v_mul_f32 v65, v65, v121
    v_mul_f32 v66, v66, v122
    v_mul_f32 v67, v67, v123
    v_mul_f32 v68, v68, v124
    v_mul_f32 v69, v69, v125
    s_add_u32 s100, s100, 64512
    buffer_load_dwordx4 v1, s[20:23], s100 offen offset:3072 lds
    ds_read_b64_tr_b16 v[60:61], v9 offset:33792
    ds_read_b64_tr_b16 v[62:63], v9 offset:34304
    s_waitcnt lgkmcnt(6)
    v_mfma_f32_32x32x16_bf16 v[80:95], v[48:51], v[208:211], v[80:95]
    v_mul_f32 v70, v70, v126
    v_mul_f32 v71, v71, v127
    v_exp_f32 v64, v64
    v_exp_f32 v65, v65
    v_exp_f32 v66, v66
    v_exp_f32 v67, v67
    ds_read_b64_tr_b16 v[48:49], v6 offset:34816
    ds_read_b64_tr_b16 v[50:51], v6 offset:35328
    s_waitcnt lgkmcnt(6)
    v_mfma_f32_32x32x16_bf16 v[80:95], v[52:55], v[212:215], v[80:95]
    v_exp_f32 v68, v68
    v_exp_f32 v69, v69
    v_exp_f32 v70, v70
    v_exp_f32 v71, v71
    v_fma_f32 v64, v64, v2, v2
    v_fma_f32 v65, v65, v2, v2
    ds_read_b64_tr_b16 v[52:53], v7 offset:34816
    ds_read_b64_tr_b16 v[54:55], v7 offset:35328
    s_waitcnt lgkmcnt(6)
    v_mfma_f32_32x32x16_bf16 v[80:95], v[56:59], v[216:219], v[80:95]
    v_fma_f32 v66, v66, v2, v2
    v_fma_f32 v67, v67, v2, v2
    v_fma_f32 v68, v68, v2, v2
    v_fma_f32 v69, v69, v2, v2
    v_fma_f32 v70, v70, v2, v2
    v_fma_f32 v71, v71, v2, v2
    ds_read_b64_tr_b16 v[56:57], v8 offset:34816
    ds_read_b64_tr_b16 v[58:59], v8 offset:35328
    s_waitcnt lgkmcnt(6)
    v_mfma_f32_32x32x16_bf16 v[80:95], v[60:63], v[220:223], v[80:95]
    v_rcp_f32 v64, v64
    v_rcp_f32 v65, v65
    v_rcp_f32 v66, v66
    v_rcp_f32 v67, v67
    v_rcp_f32 v68, v68
    v_rcp_f32 v69, v69
    ds_read_b64_tr_b16 v[60:61], v9 offset:34816
    ds_read_b64_tr_b16 v[62:63], v9 offset:35328
    s_waitcnt lgkmcnt(6)
    v_mfma_f32_32x32x16_bf16 v[80:95], v[48:51], v[224:227], v[80:95]
    v_rcp_f32 v70, v70
    v_rcp_f32 v71, v71
    v_mul_f32 v120, v120, v64
    v_mul_f32 v121, v121, v65
    v_mul_f32 v122, v122, v66
    v_mul_f32 v123, v123, v67
    ds_read_b64_tr_b16 v[48:49], v6 offset:35840
    ds_read_b64_tr_b16 v[50:51], v6 offset:36352
    s_waitcnt lgkmcnt(6)
    v_mfma_f32_32x32x16_bf16 v[80:95], v[52:55], v[228:231], v[80:95]
    v_mul_f32 v124, v124, v68
    v_mul_f32 v125, v125, v69
    v_mul_f32 v126, v126, v70
    v_mul_f32 v127, v127, v71
    v_cvt_pk_bf16_f32 v120, v120, v121
    v_cvt_pk_bf16_f32 v121, v122, v123
    ds_read_b64_tr_b16 v[52:53], v7 offset:35840
    ds_read_b64_tr_b16 v[54:55], v7 offset:36352
    s_waitcnt lgkmcnt(6)
    v_mfma_f32_32x32x16_bf16 v[80:95], v[56:59], v[232:235], v[80:95]
    v_cvt_pk_bf16_f32 v122, v124, v125
    v_cvt_pk_bf16_f32 v123, v126, v127
    buffer_store_dwordx4 v[120:123], v15, s[28:31], s81 offen offset:1024 sc1
    s_lshl_b32 s88, s65, 1
    s_sub_u32 s88, s88, 2
    v_add_u32 v42, s88, v0
    ds_read_b64_tr_b16 v[56:57], v8 offset:35840
    ds_read_b64_tr_b16 v[58:59], v8 offset:36352
    s_waitcnt lgkmcnt(6)
    v_mfma_f32_32x32x16_bf16 v[80:95], v[60:63], v[236:239], v[80:95]
    v_lshlrev_b32 v42, 14, v42
    v_add_u32 v43, -32512, v42
    v_cmp_gt_u32 vcc, 4, v0
    s_nop 1
    v_cndmask_b32 v42, v43, v42, vcc
    s_lshr_b32 s89, s99, 2
    s_lshl_b32 s89, s89, 5
    ds_read_b64_tr_b16 v[60:61], v9 offset:35840
    ds_read_b64_tr_b16 v[62:63], v9 offset:36352
    s_waitcnt lgkmcnt(6)
    v_mfma_f32_32x32x16_bf16 v[80:95], v[48:51], v[240:243], v[80:95]
    s_add_u32 s89, s89, 15728640
    s_lshl_b32 s88, s48, 26
    s_add_u32 s89, s89, s88
    v_add_u32 v42, s89, v42
    v_cmp_le_u32 vcc, 6, v0
    v_mov_b32 v43, 0x40000000
    s_waitcnt lgkmcnt(4)
    v_mfma_f32_32x32x16_bf16 v[80:95], v[52:55], v[244:247], v[80:95]
    v_cndmask_b32 v42, v42, v43, vcc
    s_cmp_eq_u32 s65, 0
    s_cselect_b32 s68, 60, 63
    s_mov_b32 s69, 0
    v_bfe_u32 v39, v0, 2, 2
    v_lshl_add_u32 v38, v27, 2, v39
    s_waitcnt lgkmcnt(2)
    v_mfma_f32_32x32x16_bf16 v[80:95], v[56:59], v[248:251], v[80:95]
    v_lshlrev_b32 v38, 7, v38
    v_bfe_u32 v36, v0, 4, 1
    v_bfe_u32 v37, v0, 1, 1
    v_lshl_add_u32 v36, v36, 1, v37
    v_and_b32 v37, 2, v39
    v_lshlrev_b32 v37, 1, v37
    s_waitcnt lgkmcnt(0)
    v_mfma_f32_32x32x16_bf16 v[80:95], v[60:63], v[252:255], v[80:95]
    v_xor_b32 v36, v36, v37
    v_lshl_add_u32 v38, v36, 4, v38
    v_and_b32 v37, 1, v0
    v_lshl_add_u32 v38, v37, 3, v38
    s_lshl_b32 s87, s76, 10
    v_add_u32 v38, s87, v38
    v_mov_b32 v6, v38
    v_xor_b32 v7, 64, v38
    v_add_u32 v12, 0x10000, v6
    v_add_u32 v13, 0x10000, v7
    v_add_u32 v22, 0x20000, v6
    v_add_u32 v23, 0x20000, v7
    s_waitcnt vmcnt(0)
    s_barrier
    s_cmp_lg_u32 s48, 0
    s_cbranch_scc1 W0_24
    buffer_store_dword v4, v3, s[28:31], s92 offen offset:512 sc1
W0_24:
    v_mul_f32 v64, v80, v80
    s_and_b32 s60, s73, 7
    s_add_u32 s60, s60, 1
    s_lshl_b32 s60, s60, 2
    s_lshr_b64 s[60:61], s[40:41], s60
    s_and_b32 s60, s60, 15
    s_add_u32 m0, s55, 32768
    s_lshl_b32 s100, s60, 18
    buffer_load_dwordx4 v1, s[20:23], s100 offen offset:0 lds
    v_mul_f32 v65, v81, v81
    s_add_u32 s100, s100, 64512
    buffer_load_dwordx4 v1, s[20:23], s100 offen offset:1024 lds
    v_mul_f32 v66, v82, v82
    s_add_u32 s100, s100, 64512
    buffer_load_dwordx4 v1, s[20:23], s100 offen offset:2048 lds
    v_mul_f32 v67, v83, v83
    s_add_u32 s100, s100, 64512
    buffer_load_dwordx4 v1, s[20:23], s100 offen offset:3072 lds
    v_mul_f32 v68, v84, v84
    buffer_load_dword v43, v42, s[28:31], 0 offen offset:0 sc1
    v_mul_f32 v69, v85, v85
    ds_read_b64_tr_b16 v[192:193], v12 offset:32768
    v_mul_f32 v70, v86, v86
    ds_read_b64_tr_b16 v[194:195], v12 offset:36864
    v_mul_f32 v71, v87, v87
    ds_read_b64_tr_b16 v[196:197], v13 offset:32768
    v_fma_f32 v64, v64, v10, v24
    ds_read_b64_tr_b16 v[198:199], v13 offset:36864
    v_fma_f32 v65, v65, v10, v24
    ds_read_b64_tr_b16 v[200:201], v12 offset:40960
    v_fma_f32 v66, v66, v10, v24
    ds_read_b64_tr_b16 v[202:203], v12 offset:45056
    v_fma_f32 v67, v67, v10, v24
    ds_read_b64_tr_b16 v[204:205], v13 offset:40960
    v_fma_f32 v68, v68, v10, v24
    ds_read_b64_tr_b16 v[206:207], v13 offset:45056
    v_fma_f32 v69, v69, v10, v24
    ds_read_b64_tr_b16 v[208:209], v12 offset:49152
    v_fma_f32 v70, v70, v10, v24
    ds_read_b64_tr_b16 v[210:211], v12 offset:53248
    v_fma_f32 v71, v71, v10, v24
    ds_read_b64_tr_b16 v[212:213], v13 offset:49152
    v_mul_f32 v64, v64, v80
    ds_read_b64_tr_b16 v[214:215], v13 offset:53248
    v_mul_f32 v65, v65, v81
    ds_read_b64_tr_b16 v[216:217], v12 offset:57344
    v_mul_f32 v66, v66, v82
    ds_read_b64_tr_b16 v[218:219], v12 offset:61440
    v_mul_f32 v67, v67, v83
    ds_read_b64_tr_b16 v[220:221], v13 offset:57344
    v_mul_f32 v68, v68, v84
    ds_read_b64_tr_b16 v[222:223], v13 offset:61440
    v_mul_f32 v69, v69, v85
    ds_read_b64_tr_b16 v[224:225], v6 offset:0
    v_mul_f32 v70, v70, v86
    ds_read_b64_tr_b16 v[226:227], v6 offset:4096
    v_mul_f32 v71, v71, v87
    ds_read_b64_tr_b16 v[228:229], v7 offset:0
    v_exp_f32 v64, v64
    ds_read_b64_tr_b16 v[230:231], v7 offset:4096
    v_exp_f32 v65, v65
    ds_read_b64_tr_b16 v[232:233], v6 offset:8192
    v_exp_f32 v66, v66
    ds_read_b64_tr_b16 v[234:235], v6 offset:12288
    v_exp_f32 v67, v67
    ds_read_b64_tr_b16 v[236:237], v7 offset:8192
    v_exp_f32 v68, v68
    ds_read_b64_tr_b16 v[238:239], v7 offset:12288
    v_exp_f32 v69, v69
    ds_read_b64_tr_b16 v[240:241], v6 offset:16384
    v_exp_f32 v70, v70
    ds_read_b64_tr_b16 v[242:243], v6 offset:20480
    v_exp_f32 v71, v71
    ds_read_b64_tr_b16 v[244:245], v7 offset:16384
    v_fma_f32 v64, v64, v2, v2
    ds_read_b64_tr_b16 v[246:247], v7 offset:20480
    v_fma_f32 v65, v65, v2, v2
    ds_read_b64_tr_b16 v[248:249], v6 offset:24576
    v_fma_f32 v66, v66, v2, v2
    ds_read_b64_tr_b16 v[250:251], v6 offset:28672
    v_fma_f32 v67, v67, v2, v2
    ds_read_b64_tr_b16 v[252:253], v7 offset:24576
    v_fma_f32 v68, v68, v2, v2
    ds_read_b64_tr_b16 v[254:255], v7 offset:28672
    v_fma_f32 v69, v69, v2, v2
    v_fma_f32 v70, v70, v2, v2
    v_fma_f32 v71, v71, v2, v2
    v_rcp_f32 v64, v64
    v_rcp_f32 v65, v65
    v_rcp_f32 v66, v66
    v_rcp_f32 v67, v67
    v_rcp_f32 v68, v68
    v_rcp_f32 v69, v69
    v_rcp_f32 v70, v70
    v_rcp_f32 v71, v71
    v_mul_f32 v80, v80, v64
    v_mul_f32 v81, v81, v65
    v_mul_f32 v82, v82, v66
    v_mul_f32 v83, v83, v67
    v_mul_f32 v84, v84, v68
    v_mul_f32 v85, v85, v69
    v_mul_f32 v86, v86, v70
    v_mul_f32 v87, v87, v71
    v_cvt_pk_bf16_f32 v80, v80, v81
    v_cvt_pk_bf16_f32 v81, v82, v83
    v_cvt_pk_bf16_f32 v82, v84, v85
    v_cvt_pk_bf16_f32 v83, v86, v87
    buffer_store_dwordx4 v[80:83], v15, s[28:31], s82 offen offset:0 sc1
    s_nop 1
    s_cmp_lg_u32 s48, 0
    s_cbranch_scc1 W0_25
    s_waitcnt vmcnt(1)
    v_cmp_ne_u32 vcc, 1, v43
    s_nop 0
    s_andn2_b64 vcc, s[68:69], vcc
    s_cmp_eq_u64 vcc, s[68:69]
    s_cbranch_scc1 KVOK_26
    s_mov_b32 s94, 0
KVLP_27:
    s_sleep 2
    buffer_load_dword v43, v42, s[28:31], 0 offen offset:0 sc1
    s_waitcnt vmcnt(0)
    s_add_u32 s94, s94, 1
    s_cmp_gt_u32 s94, 0x40000
    s_cbranch_scc1 KVOK_26
    v_cmp_ne_u32 vcc, 1, v43
    s_nop 0
    s_andn2_b64 vcc, s[68:69], vcc
    s_cmp_eq_u64 vcc, s[68:69]
    s_cbranch_scc0 KVLP_27
KVOK_26:
W0_25:
    s_waitcnt lgkmcnt(0)
    s_barrier
    s_add_u32 s89, s66, 2097152
    buffer_load_dwordx4 v[112:115], v15, s[28:31], s66 offen sc1
    buffer_load_dwordx4 v[116:119], v15, s[28:31], s66 offen offset:1024 sc1
    buffer_load_dwordx4 v[32:35], v15, s[28:31], s67 offen sc1
    buffer_load_dwordx4 v[120:123], v15, s[28:31], s89 offen sc1
    buffer_load_dwordx4 v[124:127], v15, s[28:31], s89 offen offset:1024 sc1
    v_mul_f32 v64, v88, v88
    v_mul_f32 v65, v89, v89
    v_mul_f32 v66, v90, v90
    v_mul_f32 v67, v91, v91
    v_mul_f32 v68, v92, v92
    v_mul_f32 v69, v93, v93
    v_mul_f32 v70, v94, v94
    v_mul_f32 v71, v95, v95
    v_fma_f32 v64, v64, v10, v24
    v_fma_f32 v65, v65, v10, v24
    v_fma_f32 v66, v66, v10, v24
    v_fma_f32 v67, v67, v10, v24
    v_fma_f32 v68, v68, v10, v24
    v_fma_f32 v69, v69, v10, v24
    v_fma_f32 v70, v70, v10, v24
    v_fma_f32 v71, v71, v10, v24
    v_mul_f32 v64, v64, v88
    v_mul_f32 v65, v65, v89
    v_mul_f32 v66, v66, v90
    v_mul_f32 v67, v67, v91
    v_mul_f32 v68, v68, v92
    v_mul_f32 v69, v69, v93
    v_mul_f32 v70, v70, v94
    v_mul_f32 v71, v71, v95
    v_exp_f32 v64, v64
    v_exp_f32 v65, v65
    v_exp_f32 v66, v66
    v_exp_f32 v67, v67
    v_exp_f32 v68, v68
    v_exp_f32 v69, v69
    v_exp_f32 v70, v70
    v_exp_f32 v71, v71
    v_fma_f32 v64, v64, v2, v2
    v_fma_f32 v65, v65, v2, v2
    v_fma_f32 v66, v66, v2, v2
    v_fma_f32 v67, v67, v2, v2
    v_fma_f32 v68, v68, v2, v2
    v_fma_f32 v69, v69, v2, v2
    v_fma_f32 v70, v70, v2, v2
    v_fma_f32 v71, v71, v2, v2
    v_rcp_f32 v64, v64
    v_rcp_f32 v65, v65
    v_rcp_f32 v66, v66
    v_rcp_f32 v67, v67
    v_rcp_f32 v68, v68
    v_rcp_f32 v69, v69
    v_rcp_f32 v70, v70
    v_rcp_f32 v71, v71
    v_mul_f32 v88, v88, v64
    v_mul_f32 v89, v89, v65
    v_mul_f32 v90, v90, v66
    v_mul_f32 v91, v91, v67
    v_mul_f32 v92, v92, v68
    v_mul_f32 v93, v93, v69
    v_mul_f32 v94, v94, v70
    v_mul_f32 v95, v95, v71
    v_cvt_pk_bf16_f32 v88, v88, v89
    v_cvt_pk_bf16_f32 v89, v90, v91
    v_cvt_pk_bf16_f32 v90, v92, v93
    v_cvt_pk_bf16_f32 v91, v94, v95
    buffer_store_dwordx4 v[88:91], v15, s[28:31], s82 offen offset:1024 sc1
    s_waitcnt lgkmcnt(0)
    s_nop 0
    s_add_u32 s92, s92, 1024
L_att:
    v_mov_b32 v24, v3
    v_mov_b32 v25, 1
    v_lshlrev_b32 v20, 2, v27
    v_sub_u32 v20, v26, v20
    v_mov_b32 v21, 4048155338
    s_lshr_b32 s86, s55, 2
    s_add_u32 s86, s86, 131072
    v_add_u32 v2, s86, v15
    s_lshr_b32 s87, s55, 2
    v_add_u32 v41, s87, v2
    v_and_b32 v3, 15, v0
    v_lshl_add_u32 v3, v27, 4, v3
    v_lshlrev_b32 v3, 4, v3
    v_add_u32 v3, s86, v3
    v_mov_b32 v17, 0
    v_cmp_le_i32 vcc, 0, v20
    v_cmp_le_i32 s[86:87], 1, v20
    v_cmp_le_i32 s[88:89], 2, v20
    v_cndmask_b32 v68, v21, 0, vcc
    v_cmp_le_i32 vcc, 3, v20
    v_cndmask_b32 v69, v21, 0, s[86:87]
    v_cmp_le_i32 s[86:87], 8, v20
    v_cndmask_b32 v70, v21, 0, s[88:89]
    v_cmp_le_i32 s[88:89], 9, v20
    v_cndmask_b32 v71, v21, 0, vcc
    v_cmp_le_i32 vcc, 10, v20
    v_cndmask_b32 v72, v21, 0, s[86:87]
    v_cmp_le_i32 s[86:87], 11, v20
    v_cndmask_b32 v73, v21, 0, s[88:89]
    v_cmp_le_i32 s[88:89], 16, v20
    v_cndmask_b32 v74, v21, 0, vcc
    v_cmp_le_i32 vcc, 17, v20
    v_cndmask_b32 v75, v21, 0, s[86:87]
    v_cmp_le_i32 s[86:87], 18, v20
    v_cndmask_b32 v76, v21, 0, s[88:89]
    v_cmp_le_i32 s[88:89], 19, v20
    v_cndmask_b32 v77, v21, 0, vcc
    v_cmp_le_i32 vcc, 24, v20
    v_cndmask_b32 v78, v21, 0, s[86:87]
    v_cmp_le_i32 s[86:87], 25, v20
    v_cndmask_b32 v79, v21, 0, s[88:89]
    v_cmp_le_i32 s[88:89], 26, v20
    v_cndmask_b32 v80, v21, 0, vcc
    v_cmp_le_i32 vcc, 27, v20
    v_cndmask_b32 v81, v21, 0, s[86:87]
    v_cndmask_b32 v82, v21, 0, s[88:89]
    v_cndmask_b32 v83, v21, 0, vcc
    v_mov_b32 v8, v14
    v_mov_b32 v9, v14
    v_mov_b32 v10, v14
    v_mov_b32 v11, v14
    v_mov_b32 v44, v14
    v_mov_b32 v45, v14
    v_mov_b32 v46, v14
    v_mov_b32 v47, v14
    v_mov_b32 v48, v14
    v_mov_b32 v49, v14
    v_mov_b32 v50, v14
    v_mov_b32 v51, v14
    v_mov_b32 v52, v14
    v_mov_b32 v53, v14
    v_mov_b32 v54, v14
    v_mov_b32 v55, v14
    v_mov_b32 v56, v14
    v_mov_b32 v57, v14
    v_mov_b32 v58, v14
    v_mov_b32 v59, v14
    s_lshr_b32 s87, s95, 1
    s_lshl_b32 s87, s87, 14
    s_lshl_b32 s86, s48, 26
    s_add_u32 s86, s86, 15728640
    s_add_u32 s86, s86, s87
    v_lshl_add_u32 v28, v26, 5, s86
    v_lshl_add_u32 v28, v27, 29, v28
    s_mov_b32 s90, 0xffff
    s_mov_b32 s91, 0xffff
    v_mov_b32 v29, 131072
    v_lshrrev_b32 v5, 1, v0
    v_lshlrev_b32 v5, 26, v5
    v_lshl_add_u32 v5, v0, 14, v5
    s_mov_b32 s68, 0xff
    buffer_load_dword v30, v28, s[28:31], 0 offen offset:512 sc1
    s_waitcnt vmcnt(6)
    ds_write_b128 v41, v[112:115]
    s_waitcnt vmcnt(5)
    ds_write_b128 v41, v[116:119] offset:1024
    s_waitcnt vmcnt(3)
    ds_write_b128 v41, v[120:123] offset:16384
    s_waitcnt vmcnt(2)
    ds_write_b128 v41, v[124:127] offset:17408
    v_sub_f32 v116, v21, v68
    v_sub_f32 v117, v21, v69
    v_sub_f32 v118, v21, v70
    v_sub_f32 v119, v21, v71
    v_sub_f32 v120, v21, v72
    v_sub_f32 v121, v21, v73
    v_sub_f32 v122, v21, v74
    v_sub_f32 v123, v21, v75
    v_sub_f32 v124, v21, v76
    v_sub_f32 v125, v21, v77
    v_sub_f32 v126, v21, v78
    v_sub_f32 v127, v21, v79
    v_sub_f32 v128, v21, v80
    v_sub_f32 v129, v21, v81
    v_sub_f32 v130, v21, v82
    v_sub_f32 v131, v21, v83
    s_nop 1
    s_cmp_lg_u32 s48, 0
    s_cbranch_scc1 W0_28
    ds_write_b32 v29, v17
    s_waitcnt vmcnt(0)
    v_cmp_ne_u32 vcc, 1, v30
    s_nop 0
    s_andn2_b64 vcc, s[68:69], vcc
    s_cmp_eq_u64 vcc, s[68:69]
    s_cbranch_scc1 HBOK_29
    s_mov_b32 s94, 0
HBLP_30:
    s_sleep 2
    buffer_load_dword v30, v28, s[28:31], 0 offen offset:512 sc1
    s_waitcnt vmcnt(0)
    s_add_u32 s94, s94, 1
    s_cmp_gt_u32 s94, 0x40000
    s_cbranch_scc1 HBOK_29
    v_cmp_ne_u32 vcc, 1, v30
    s_nop 0
    s_andn2_b64 vcc, s[68:69], vcc
    s_cmp_eq_u64 vcc, s[68:69]
    s_cbranch_scc0 HBLP_30
HBOK_29:
    s_waitcnt lgkmcnt(0)
W0_28:
    s_waitcnt vmcnt(1)
    s_waitcnt lgkmcnt(0)
    s_barrier
    s_cmp_lg_u32 s48, 0
    s_cbranch_scc1 W0_31
    buffer_store_dword v25, v24, s[28:31], s92 offen offset:0 sc1
W0_31:
    ds_read_b128 v[36:39], v2 offset:8192
    ds_read_b128 v[40:43], v2 offset:7168
    s_waitcnt lgkmcnt(1)
    v_mfma_f32_32x32x16_bf16 v[68:83], v[36:39], v[32:35], v[68:83]
    s_mov_b64 exec, s[90:91]
    ds_read_b128 v[44:47], v3 offset:24576
    ds_read_b128 v[48:51], v3 offset:25088
    s_mov_b64 exec, -1
    s_nop 7
    v_max3_f32 v20, v68, v69, v70
    v_max3_f32 v21, v71, v72, v73
    v_max3_f32 v21, v74, v75, v21
    v_max3_f32 v20, v76, v77, v20
    v_max3_f32 v21, v78, v79, v21
    v_max3_f32 v20, v80, v81, v20
    v_max3_f32 v21, v82, v83, v21
PASS2_32:
    v_max_f32 v20, v20, v21
    v_mov_b32 v21, v20
    s_nop 1
    v_permlane32_swap_b32 v20, v21
    v_max_f32 v20, v20, v21
    v_cvt_pk_bf16_f32 v21, v20, v20
    v_lshlrev_b32 v21, 16, v21
    v_sub_f32 v21, v21, v20
    v_cvt_pk_bf16_f32 v16, -v20, v21
    v_cmp_eq_u32 vcc, 0, v27
    s_nop 1
    v_cndmask_b32 v16, 0, v16, vcc
    s_nop 1
    v_mfma_f32_32x32x16_bf16 v[68:83], v[8:11], v[16:19], v[68:83]
    v_mfma_f32_32x32x16_bf16 v[100:115], v[8:11], v[16:19], 0
    s_waitcnt lgkmcnt(2)
    v_mfma_f32_32x32x16_bf16 v[84:99], v[40:43], v[32:35], v[100:115]
    ds_read_b128 v[36:39], v2 offset:6144
    s_mov_b64 exec, s[90:91]
    ds_read_b128 v[52:55], v3 offset:23552
    ds_read_b128 v[56:59], v3 offset:24064
    s_mov_b64 exec, -1
    s_nop 3
    v_exp_f32 v68, v68
    v_exp_f32 v69, v69
    v_exp_f32 v70, v70
    v_exp_f32 v71, v71
    s_bfe_u32 s60, s73, 0x10003
    s_xor_b32 s60, s60, 0
    s_add_u32 s60, s60, 2
    s_lshl_b32 s62, s60, 14
    s_add_u32 s62, s62, s71
    buffer_load_dwordx4 v[148:151], v15, s[28:31], s62 offen offset:0 sc1
    buffer_load_dwordx4 v[152:155], v15, s[28:31], s62 offen offset:1024 sc1
    v_exp_f32 v72, v72
    v_exp_f32 v73, v73
    v_exp_f32 v74, v74
    v_exp_f32 v75, v75
    v_cvt_pk_bf16_f32 v60, v68, v69
    v_cvt_pk_bf16_f32 v61, v70, v71
    v_cvt_pk_bf16_f32 v62, v72, v73
    v_cvt_pk_bf16_f32 v63, v74, v75
    buffer_load_dwordx4 v[156:159], v15, s[28:31], s62 offen offset:2048 sc1
    buffer_load_dwordx4 v[160:163], v15, s[28:31], s62 offen offset:3072 sc1
    s_waitcnt lgkmcnt(4)
    v_mfma_f32_32x32x16_bf16 v[132:147], v[44:47], v[60:63], 0
    v_exp_f32 v76, v76
    v_exp_f32 v77, v77
    v_exp_f32 v78, v78
    v_exp_f32 v79, v79
    s_and_b32 s60, s73, 7
    s_add_u32 s60, s60, 2
    s_lshl_b32 s60, s60, 2
    s_lshr_b64 s[60:61], s[40:41], s60
    s_and_b32 s60, s60, 15
    s_add_u32 m0, s55, 98304
    s_lshl_b32 s100, s60, 18
    buffer_load_dwordx4 v1, s[20:23], s100 offen offset:0 lds
    v_exp_f32 v80, v80
    v_exp_f32 v81, v81
    v_exp_f32 v82, v82
    v_exp_f32 v83, v83
    v_cvt_pk_bf16_f32 v64, v76, v77
    v_cvt_pk_bf16_f32 v65, v78, v79
    v_cvt_pk_bf16_f32 v66, v80, v81
    v_cvt_pk_bf16_f32 v67, v82, v83
    s_waitcnt lgkmcnt(3)
    s_nop 0
    v_mfma_f32_32x32x16_bf16 v[132:147], v[48:51], v[64:67], v[132:147]
    s_cmp_eq_u32 s75, 8
    s_cbranch_scc1 TAIL8_40
    s_waitcnt lgkmcnt(2)
    v_mfma_f32_32x32x16_bf16 v[68:83], v[36:39], v[32:35], v[100:115]
    ds_read_b128 v[40:43], v2 offset:5120
    s_mov_b64 exec, s[90:91]
    ds_read_b128 v[44:47], v3 offset:22528
    ds_read_b128 v[48:51], v3 offset:23040
    s_mov_b64 exec, -1
    v_exp_f32 v84, v84
    v_exp_f32 v85, v85
    v_exp_f32 v86, v86
    v_exp_f32 v87, v87
    s_add_u32 s100, s100, 64512
    buffer_load_dwordx4 v1, s[20:23], s100 offen offset:1024 lds
    v_exp_f32 v88, v88
    v_exp_f32 v89, v89
    v_exp_f32 v90, v90
    v_exp_f32 v91, v91
    v_cvt_pk_bf16_f32 v60, v84, v85
    v_cvt_pk_bf16_f32 v61, v86, v87
    v_cvt_pk_bf16_f32 v62, v88, v89
    v_cvt_pk_bf16_f32 v63, v90, v91
    s_add_u32 s100, s100, 64512
    buffer_load_dwordx4 v1, s[20:23], s100 offen offset:2048 lds
    s_waitcnt lgkmcnt(4)
    v_mfma_f32_32x32x16_bf16 v[132:147], v[52:55], v[60:63], v[132:147]
    v_exp_f32 v92, v92
    v_exp_f32 v93, v93
    v_exp_f32 v94, v94
    v_exp_f32 v95, v95
    s_add_u32 s100, s100, 64512
    buffer_load_dwordx4 v1, s[20:23], s100 offen offset:3072 lds
    v_exp_f32 v96, v96
    v_exp_f32 v97, v97
    v_exp_f32 v98, v98
    v_exp_f32 v99, v99
    v_cvt_pk_bf16_f32 v64, v92, v93
    v_cvt_pk_bf16_f32 v65, v94, v95
    v_cvt_pk_bf16_f32 v66, v96, v97
    v_cvt_pk_bf16_f32 v67, v98, v99
    s_waitcnt lgkmcnt(3)
    s_nop 0
    v_mfma_f32_32x32x16_bf16 v[132:147], v[56:59], v[64:67], v[132:147]
    s_cmp_eq_u32 s75, 7
    s_cbranch_scc1 TAIL7_39
    s_waitcnt lgkmcnt(2)
    v_mfma_f32_32x32x16_bf16 v[84:99], v[40:43], v[32:35], v[100:115]
    ds_read_b128 v[36:39], v2 offset:4096
    s_mov_b64 exec, s[90:91]
    ds_read_b128 v[52:55], v3 offset:21504
    ds_read_b128 v[56:59], v3 offset:22016
    s_mov_b64 exec, -1
    v_exp_f32 v68, v68
    v_exp_f32 v69, v69
    v_exp_f32 v70, v70
    v_exp_f32 v71, v71
    s_bfe_u32 s60, s73, 0x10003
    s_xor_b32 s60, s60, 1
    s_add_u32 s60, s60, 2
    s_lshl_b32 s62, s60, 14
    s_add_u32 s62, s62, s71
    buffer_load_dwordx4 v[164:167], v15, s[28:31], s62 offen offset:0 sc1
    buffer_load_dwordx4 v[168:171], v15, s[28:31], s62 offen offset:1024 sc1
    v_exp_f32 v72, v72
    v_exp_f32 v73, v73
    v_exp_f32 v74, v74
    v_exp_f32 v75, v75
    v_cvt_pk_bf16_f32 v60, v68, v69
    v_cvt_pk_bf16_f32 v61, v70, v71
    v_cvt_pk_bf16_f32 v62, v72, v73
    v_cvt_pk_bf16_f32 v63, v74, v75
    buffer_load_dwordx4 v[172:175], v15, s[28:31], s62 offen offset:2048 sc1
    buffer_load_dwordx4 v[176:179], v15, s[28:31], s62 offen offset:3072 sc1
    s_waitcnt lgkmcnt(4)
    v_mfma_f32_32x32x16_bf16 v[132:147], v[44:47], v[60:63], v[132:147]
    v_exp_f32 v76, v76
    v_exp_f32 v77, v77
    v_exp_f32 v78, v78
    v_exp_f32 v79, v79
    v_exp_f32 v80, v80
    v_exp_f32 v81, v81
    v_exp_f32 v82, v82
    v_exp_f32 v83, v83
    v_cvt_pk_bf16_f32 v64, v76, v77
    v_cvt_pk_bf16_f32 v65, v78, v79
    v_cvt_pk_bf16_f32 v66, v80, v81
    v_cvt_pk_bf16_f32 v67, v82, v83
    s_waitcnt lgkmcnt(3)
    s_nop 0
    v_mfma_f32_32x32x16_bf16 v[132:147], v[48:51], v[64:67], v[132:147]
    s_cmp_eq_u32 s75, 6
    s_cbranch_scc1 TAIL6_38
    s_waitcnt lgkmcnt(2)
    v_mfma_f32_32x32x16_bf16 v[68:83], v[36:39], v[32:35], v[100:115]
    ds_read_b128 v[40:43], v2 offset:3072
    s_mov_b64 exec, s[90:91]
    ds_read_b128 v[44:47], v3 offset:20480
    ds_read_b128 v[48:51], v3 offset:20992
    s_mov_b64 exec, -1
    v_exp_f32 v84, v84
    v_exp_f32 v85, v85
    v_exp_f32 v86, v86
    v_exp_f32 v87, v87
    s_and_b32 s60, s73, 7
    s_add_u32 s60, s60, 3
    s_lshl_b32 s60, s60, 2
    s_lshr_b64 s[60:61], s[40:41], s60
    s_and_b32 s60, s60, 15
    s_add_u32 m0, s55, 0
    s_lshl_b32 s100, s60, 18
    buffer_load_dwordx4 v1, s[20:23], s100 offen offset:0 lds
    v_exp_f32 v88, v88
    v_exp_f32 v89, v89
    v_exp_f32 v90, v90
    v_exp_f32 v91, v91
    v_cvt_pk_bf16_f32 v60, v84, v85
    v_cvt_pk_bf16_f32 v61, v86, v87
    v_cvt_pk_bf16_f32 v62, v88, v89
    v_cvt_pk_bf16_f32 v63, v90, v91
    s_add_u32 s100, s100, 64512
    buffer_load_dwordx4 v1, s[20:23], s100 offen offset:1024 lds
    s_waitcnt lgkmcnt(4)
    v_mfma_f32_32x32x16_bf16 v[132:147], v[52:55], v[60:63], v[132:147]
    v_exp_f32 v92, v92
    v_exp_f32 v93, v93
    v_exp_f32 v94, v94
    v_exp_f32 v95, v95
    v_exp_f32 v96, v96
    v_exp_f32 v97, v97
    v_exp_f32 v98, v98
    v_exp_f32 v99, v99
    v_cvt_pk_bf16_f32 v64, v92, v93
    v_cvt_pk_bf16_f32 v65, v94, v95
    v_cvt_pk_bf16_f32 v66, v96, v97
    v_cvt_pk_bf16_f32 v67, v98, v99
    s_waitcnt lgkmcnt(3)
    s_nop 0
    v_mfma_f32_32x32x16_bf16 v[132:147], v[56:59], v[64:67], v[132:147]
    s_cmp_eq_u32 s75, 5
    s_cbranch_scc1 TAIL5_37
    s_waitcnt lgkmcnt(2)
    v_mfma_f32_32x32x16_bf16 v[84:99], v[40:43], v[32:35], v[100:115]
    ds_read_b128 v[36:39], v2 offset:2048
    s_mov_b64 exec, s[90:91]
    ds_read_b128 v[52:55], v3 offset:19456
    ds_read_b128 v[56:59], v3 offset:19968
    s_mov_b64 exec, -1
    v_exp_f32 v68, v68
    v_exp_f32 v69, v69
    v_exp_f32 v70, v70
    v_exp_f32 v71, v71
    s_add_u32 s100, s100, 64512
    buffer_load_dwordx4 v1, s[20:23], s100 offen offset:2048 lds
    v_exp_f32 v72, v72
    v_exp_f32 v73, v73
    v_exp_f32 v74, v74
    v_exp_f32 v75, v75
    v_cvt_pk_bf16_f32 v60, v68, v69
    v_cvt_pk_bf16_f32 v61, v70, v71
    v_cvt_pk_bf16_f32 v62, v72, v73
    v_cvt_pk_bf16_f32 v63, v74, v75
    s_add_u32 s100, s100, 64512
    buffer_load_dwordx4 v1, s[20:23], s100 offen offset:3072 lds
    s_waitcnt lgkmcnt(4)
    v_mfma_f32_32x32x16_bf16 v[132:147], v[44:47], v[60:63], v[132:147]
    v_exp_f32 v76, v76
    v_exp_f32 v77, v77
    v_exp_f32 v78, v78
    v_exp_f32 v79, v79
    s_waitcnt vmcnt(16)
    buffer_load_dword v30, v28, s[28:31], 0 offen offset:768 sc1
    v_exp_f32 v80, v80
    v_exp_f32 v81, v81
    v_exp_f32 v82, v82
    v_exp_f32 v83, v83
    v_cvt_pk_bf16_f32 v64, v76, v77
    v_cvt_pk_bf16_f32 v65, v78, v79
    v_cvt_pk_bf16_f32 v66, v80, v81
    v_cvt_pk_bf16_f32 v67, v82, v83
    s_waitcnt lgkmcnt(3)
    s_nop 0
    v_mfma_f32_32x32x16_bf16 v[132:147], v[48:51], v[64:67], v[132:147]
    s_cmp_eq_u32 s75, 4
    s_cbranch_scc1 TAIL4_36
    s_waitcnt lgkmcnt(2)
    v_mfma_f32_32x32x16_bf16 v[68:83], v[36:39], v[32:35], v[100:115]
    ds_read_b128 v[40:43], v2 offset:1024
    s_mov_b64 exec, s[90:91]
    ds_read_b128 v[44:47], v3 offset:18432
    ds_read_b128 v[48:51], v3 offset:18944
    s_mov_b64 exec, -1
    v_exp_f32 v84, v84
    v_exp_f32 v85, v85
    v_exp_f32 v86, v86
    v_exp_f32 v87, v87
    v_exp_f32 v88, v88
    v_exp_f32 v89, v89
    v_exp_f32 v90, v90
    v_exp_f32 v91, v91
    v_cvt_pk_bf16_f32 v60, v84, v85
    v_cvt_pk_bf16_f32 v61, v86, v87
    v_cvt_pk_bf16_f32 v62, v88, v89
    v_cvt_pk_bf16_f32 v63, v90, v91
    s_waitcnt lgkmcnt(4)
    s_nop 0
    v_mfma_f32_32x32x16_bf16 v[132:147], v[52:55], v[60:63], v[132:147]
    v_exp_f32 v92, v92
    v_exp_f32 v93, v93
    v_exp_f32 v94, v94
    v_exp_f32 v95, v95
    v_exp_f32 v96, v96
    v_exp_f32 v97, v97
    v_exp_f32 v98, v98
    v_exp_f32 v99, v99
    v_cvt_pk_bf16_f32 v64, v92, v93
    v_cvt_pk_bf16_f32 v65, v94, v95
    v_cvt_pk_bf16_f32 v66, v96, v97
    v_cvt_pk_bf16_f32 v67, v98, v99
    s_waitcnt lgkmcnt(3)
    s_nop 0
    v_mfma_f32_32x32x16_bf16 v[132:147], v[56:59], v[64:67], v[132:147]
    s_cmp_eq_u32 s75, 3
    s_cbranch_scc1 TAIL3_35
    s_waitcnt lgkmcnt(2)
    v_mfma_f32_32x32x16_bf16 v[84:99], v[40:43], v[32:35], v[100:115]
    ds_read_b128 v[36:39], v2 offset:0
    s_mov_b64 exec, s[90:91]
    ds_read_b128 v[52:55], v3 offset:17408
    ds_read_b128 v[56:59], v3 offset:17920
    s_mov_b64 exec, -1
    v_exp_f32 v68, v68
    v_exp_f32 v69, v69
    v_exp_f32 v70, v70
    v_exp_f32 v71, v71
    s_nop 2
    s_cmp_lg_u32 s48, 0
    s_cbranch_scc1 W0_42
    s_mov_b32 s68, 0xffff
    s_waitcnt vmcnt(0)
    v_cmp_ne_u32 vcc, 1, v30
    s_nop 0
    s_andn2_b64 vcc, s[68:69], vcc
    s_cmp_eq_u64 vcc, s[68:69]
    s_cbranch_scc1 HCOK_43
    s_mov_b32 s94, 0
HCLP_44:
    s_sleep 2
    buffer_load_dword v30, v28, s[28:31], 0 offen offset:768 sc1
    s_waitcnt vmcnt(0)
    s_add_u32 s94, s94, 1
    s_cmp_gt_u32 s94, 0x40000
    s_cbranch_scc1 HCOK_43
    v_cmp_ne_u32 vcc, 1, v30
    s_nop 0
    s_andn2_b64 vcc, s[68:69], vcc
    s_cmp_eq_u64 vcc, s[68:69]
    s_cbranch_scc0 HCLP_44
HCOK_43:
    ds_write_b32 v29, v25
W0_42:
    v_exp_f32 v72, v72
    v_exp_f32 v73, v73
    v_exp_f32 v74, v74
    v_exp_f32 v75, v75
    v_cvt_pk_bf16_f32 v60, v68, v69
    v_cvt_pk_bf16_f32 v61, v70, v71
    v_cvt_pk_bf16_f32 v62, v72, v73
    v_cvt_pk_bf16_f32 v63, v74, v75
    s_waitcnt lgkmcnt(4)
    s_nop 0
    v_mfma_f32_32x32x16_bf16 v[132:147], v[44:47], v[60:63], v[132:147]
    v_exp_f32 v76, v76
    v_exp_f32 v77, v77
    v_exp_f32 v78, v78
    v_exp_f32 v79, v79
    v_exp_f32 v80, v80
    v_exp_f32 v81, v81
    v_exp_f32 v82, v82
    v_exp_f32 v83, v83
    v_cvt_pk_bf16_f32 v64, v76, v77
    v_cvt_pk_bf16_f32 v65, v78, v79
    v_cvt_pk_bf16_f32 v66, v80, v81
    v_cvt_pk_bf16_f32 v67, v82, v83
    s_waitcnt lgkmcnt(3)
    s_nop 0
    v_mfma_f32_32x32x16_bf16 v[132:147], v[48:51], v[64:67], v[132:147]
    s_cmp_eq_u32 s75, 2
    s_cbranch_scc1 TAIL2_34
    v_mfma_f32_32x32x16_bf16 v[68:83], v[8:11], v[16:19], v[116:131]
    s_waitcnt lgkmcnt(2)
    v_mfma_f32_32x32x16_bf16 v[68:83], v[36:39], v[32:35], v[68:83]
    s_mov_b64 exec, s[90:91]
    ds_read_b128 v[44:47], v3 offset:16384
    ds_read_b128 v[48:51], v3 offset:16896
    s_mov_b64 exec, -1
    v_exp_f32 v84, v84
    v_exp_f32 v85, v85
    v_exp_f32 v86, v86
    v_exp_f32 v87, v87
    s_nop 3
    s_mov_b32 s94, 0
HCW_45:
    ds_read_b32 v21, v29
    s_add_u32 s94, s94, 1
    s_waitcnt lgkmcnt(0)
    v_readfirstlane_b32 s86, v21
    s_cmp_gt_u32 s94, 0x1000000
    s_cbranch_scc1 HCD_46
    s_cmp_eq_u32 s86, 0
    s_cbranch_scc1 HCW_45
HCD_46:
    v_exp_f32 v88, v88
    v_exp_f32 v89, v89
    v_exp_f32 v90, v90
    v_exp_f32 v91, v91
    v_cvt_pk_bf16_f32 v60, v84, v85
    v_cvt_pk_bf16_f32 v61, v86, v87
    v_cvt_pk_bf16_f32 v62, v88, v89
    v_cvt_pk_bf16_f32 v63, v90, v91
    s_and_b32 s60, s73, 7
    s_add_u32 s60, s60, 0
    s_lshl_b32 s60, s60, 2
    s_lshr_b64 s[60:61], s[40:41], s60
    s_and_b32 s60, s60, 15
    s_lshl_b32 s62, s60, 14
    s_add_u32 s62, s62, s71
    buffer_load_dwordx4 v[180:183], v15, s[28:31], s62 offen offset:0 sc1
    v_mfma_f32_32x32x16_bf16 v[132:147], v[52:55], v[60:63], v[132:147]
    v_exp_f32 v92, v92
    v_exp_f32 v93, v93
    v_exp_f32 v94, v94
    v_exp_f32 v95, v95
    buffer_load_dwordx4 v[184:187], v15, s[28:31], s62 offen offset:1024 sc1
    v_exp_f32 v96, v96
    v_exp_f32 v97, v97
    v_exp_f32 v98, v98
    v_exp_f32 v99, v99
    v_cvt_pk_bf16_f32 v64, v92, v93
    v_cvt_pk_bf16_f32 v65, v94, v95
    v_cvt_pk_bf16_f32 v66, v96, v97
    v_cvt_pk_bf16_f32 v67, v98, v99
    s_nop 1
    v_mfma_f32_32x32x16_bf16 v[132:147], v[56:59], v[64:67], v[132:147]
    buffer_load_dwordx4 v[188:191], v15, s[28:31], s62 offen offset:2048 sc1
    s_cmp_eq_u32 s75, 1
    s_cbranch_scc1 TAIL1_33
    v_exp_f32 v68, v68
    v_exp_f32 v69, v69
    v_exp_f32 v70, v70
    v_exp_f32 v71, v71
    v_exp_f32 v72, v72
    v_exp_f32 v73, v73
    v_exp_f32 v74, v74
    v_exp_f32 v75, v75
    v_cvt_pk_bf16_f32 v60, v68, v69
    v_cvt_pk_bf16_f32 v61, v70, v71
    v_cvt_pk_bf16_f32 v62, v72, v73
    v_cvt_pk_bf16_f32 v63, v74, v75
    s_nop 1
    v_mfma_f32_32x32x16_bf16 v[132:147], v[44:47], v[60:63], v[132:147]
    v_exp_f32 v76, v76
    v_exp_f32 v77, v77
    v_exp_f32 v78, v78
    v_exp_f32 v79, v79
    v_exp_f32 v80, v80
    v_exp_f32 v81, v81
    v_exp_f32 v82, v82
    v_exp_f32 v83, v83
    v_cvt_pk_bf16_f32 v64, v76, v77
    v_cvt_pk_bf16_f32 v65, v78, v79
    v_cvt_pk_bf16_f32 v66, v80, v81
    v_cvt_pk_bf16_f32 v67, v82, v83
    s_nop 1
    v_mfma_f32_32x32x16_bf16 v[132:147], v[48:51], v[64:67], v[132:147]
    s_branch P2END_41
TAIL8_40:
    s_nop 9
    s_add_u32 s100, s100, 64512
    buffer_load_dwordx4 v1, s[20:23], s100 offen offset:1024 lds
    s_add_u32 s100, s100, 64512
    buffer_load_dwordx4 v1, s[20:23], s100 offen offset:2048 lds
    s_add_u32 s100, s100, 64512
    buffer_load_dwordx4 v1, s[20:23], s100 offen offset:3072 lds
TAIL7_39:
    s_bfe_u32 s60, s73, 0x10003
    s_xor_b32 s60, s60, 1
    s_add_u32 s60, s60, 2
    s_lshl_b32 s62, s60, 14
    s_add_u32 s62, s62, s71
    buffer_load_dwordx4 v[164:167], v15, s[28:31], s62 offen offset:0 sc1
    buffer_load_dwordx4 v[168:171], v15, s[28:31], s62 offen offset:1024 sc1
    buffer_load_dwordx4 v[172:175], v15, s[28:31], s62 offen offset:2048 sc1
    buffer_load_dwordx4 v[176:179], v15, s[28:31], s62 offen offset:3072 sc1
TAIL6_38:
    s_and_b32 s60, s73, 7
    s_add_u32 s60, s60, 3
    s_lshl_b32 s60, s60, 2
    s_lshr_b64 s[60:61], s[40:41], s60
    s_and_b32 s60, s60, 15
    s_add_u32 m0, s55, 0
    s_lshl_b32 s100, s60, 18
    buffer_load_dwordx4 v1, s[20:23], s100 offen offset:0 lds
    s_add_u32 s100, s100, 64512
    buffer_load_dwordx4 v1, s[20:23], s100 offen offset:1024 lds
TAIL5_37:
    s_add_u32 s100, s100, 64512
    buffer_load_dwordx4 v1, s[20:23], s100 offen offset:2048 lds
    s_add_u32 s100, s100, 64512
    buffer_load_dwordx4 v1, s[20:23], s100 offen offset:3072 lds
    s_waitcnt vmcnt(16)
    buffer_load_dword v30, v28, s[28:31], 0 offen offset:768 sc1
TAIL4_36:
TAIL3_35:
    s_cmp_lg_u32 s48, 0
    s_cbranch_scc1 W0_47
    s_mov_b32 s68, 0xffff
    s_waitcnt vmcnt(0)
    v_cmp_ne_u32 vcc, 1, v30
    s_nop 0
    s_andn2_b64 vcc, s[68:69], vcc
    s_cmp_eq_u64 vcc, s[68:69]
    s_cbranch_scc1 HCOK_48
    s_mov_b32 s94, 0
HCLP_49:
    s_sleep 2
    buffer_load_dword v30, v28, s[28:31], 0 offen offset:768 sc1
    s_waitcnt vmcnt(0)
    s_add_u32 s94, s94, 1
    s_cmp_gt_u32 s94, 0x40000
    s_cbranch_scc1 HCOK_48
    v_cmp_ne_u32 vcc, 1, v30
    s_nop 0
    s_andn2_b64 vcc, s[68:69], vcc
    s_cmp_eq_u64 vcc, s[68:69]
    s_cbranch_scc0 HCLP_49
HCOK_48:
    ds_write_b32 v29, v25
W0_47:
TAIL2_34:
    s_mov_b32 s94, 0
HCW_50:
    ds_read_b32 v21, v29
    s_add_u32 s94, s94, 1
    s_waitcnt lgkmcnt(0)
    v_readfirstlane_b32 s86, v21
    s_cmp_gt_u32 s94, 0x1000000
    s_cbranch_scc1 HCD_51
    s_cmp_eq_u32 s86, 0
    s_cbranch_scc1 HCW_50
HCD_51:
    s_and_b32 s60, s73, 7
    s_add_u32 s60, s60, 0
    s_lshl_b32 s60, s60, 2
    s_lshr_b64 s[60:61], s[40:41], s60
    s_and_b32 s60, s60, 15
    s_lshl_b32 s62, s60, 14
    s_add_u32 s62, s62, s71
    buffer_load_dwordx4 v[180:183], v15, s[28:31], s62 offen offset:0 sc1
    buffer_load_dwordx4 v[184:187], v15, s[28:31], s62 offen offset:1024 sc1
    buffer_load_dwordx4 v[188:191], v15, s[28:31], s62 offen offset:2048 sc1
TAIL1_33:
P2END_41:
    s_waitcnt lgkmcnt(0)
    s_nop 11
    v_mov_b32 v21, 1317011456
    v_cmp_nle_f32 vcc, v140, v21
    s_nop 0
    s_cmp_eq_u64 vcc, 0
    s_cbranch_scc1 SMOK_52
    s_cmp_lg_u32 s72, 0
    s_cbranch_scc1 SMOK_52
    s_mov_b32 s72, 1
    s_waitcnt vmcnt(0) lgkmcnt(0)
    v_mov_b32 v20, 4048155338
    v_mov_b32 v21, 4048155338
    v_mov_b32 v30, 4048155338
    s_cmp_gt_u32 s75, 0
    s_cbranch_scc1 RSK_53
    ds_read_b128 v[36:39], v2 offset:0
    s_waitcnt lgkmcnt(0)
    v_mfma_f32_32x32x16_bf16 v[68:83], v[36:39], v[32:35], v[116:131]
    s_nop 11
    v_max3_f32 v20, v68, v69, v20
    v_max3_f32 v21, v70, v71, v21
    v_max3_f32 v20, v72, v73, v20
    v_max3_f32 v21, v74, v75, v21
    v_max3_f32 v20, v76, v77, v20
    v_max3_f32 v21, v78, v79, v21
    v_max3_f32 v20, v80, v81, v20
    v_max3_f32 v21, v82, v83, v21
    s_nop 1
RSK_53:
    s_cmp_gt_u32 s75, 1
    s_cbranch_scc1 RSK_54
    ds_read_b128 v[36:39], v2 offset:1024
    s_waitcnt lgkmcnt(0)
    v_mfma_f32_32x32x16_bf16 v[68:83], v[36:39], v[32:35], 0
    s_nop 11
    v_max3_f32 v20, v68, v69, v20
    v_max3_f32 v21, v70, v71, v21
    v_max3_f32 v20, v72, v73, v20
    v_max3_f32 v21, v74, v75, v21
    v_max3_f32 v20, v76, v77, v20
    v_max3_f32 v21, v78, v79, v21
    v_max3_f32 v20, v80, v81, v20
    v_max3_f32 v21, v82, v83, v21
    s_nop 1
RSK_54:
    s_cmp_gt_u32 s75, 2
    s_cbranch_scc1 RSK_55
    ds_read_b128 v[36:39], v2 offset:2048
    s_waitcnt lgkmcnt(0)
    v_mfma_f32_32x32x16_bf16 v[68:83], v[36:39], v[32:35], 0
    s_nop 11
    v_max3_f32 v20, v68, v69, v20
    v_max3_f32 v21, v70, v71, v21
    v_max3_f32 v20, v72, v73, v20
    v_max3_f32 v21, v74, v75, v21
    v_max3_f32 v20, v76, v77, v20
    v_max3_f32 v21, v78, v79, v21
    v_max3_f32 v20, v80, v81, v20
    v_max3_f32 v21, v82, v83, v21
    s_nop 1
RSK_55:
    s_cmp_gt_u32 s75, 3
    s_cbranch_scc1 RSK_56
    ds_read_b128 v[36:39], v2 offset:3072
    s_waitcnt lgkmcnt(0)
    v_mfma_f32_32x32x16_bf16 v[68:83], v[36:39], v[32:35], 0
    s_nop 11
    v_max3_f32 v20, v68, v69, v20
    v_max3_f32 v21, v70, v71, v21
    v_max3_f32 v20, v72, v73, v20
    v_max3_f32 v21, v74, v75, v21
    v_max3_f32 v20, v76, v77, v20
    v_max3_f32 v21, v78, v79, v21
    v_max3_f32 v20, v80, v81, v20
    v_max3_f32 v21, v82, v83, v21
    s_nop 1
RSK_56:
    s_cmp_gt_u32 s75, 4
    s_cbranch_scc1 RSK_57
    ds_read_b128 v[36:39], v2 offset:4096
    s_waitcnt lgkmcnt(0)
    v_mfma_f32_32x32x16_bf16 v[68:83], v[36:39], v[32:35], 0
    s_nop 11
    v_max3_f32 v20, v68, v69, v20
    v_max3_f32 v21, v70, v71, v21
    v_max3_f32 v20, v72, v73, v20
    v_max3_f32 v21, v74, v75, v21
    v_max3_f32 v20, v76, v77, v20
    v_max3_f32 v21, v78, v79, v21
    v_max3_f32 v20, v80, v81, v20
    v_max3_f32 v21, v82, v83, v21
    s_nop 1
RSK_57:
    s_cmp_gt_u32 s75, 5
    s_cbranch_scc1 RSK_58
    ds_read_b128 v[36:39], v2 offset:5120
    s_waitcnt lgkmcnt(0)
    v_mfma_f32_32x32x16_bf16 v[68:83], v[36:39], v[32:35], 0
    s_nop 11
    v_max3_f32 v20, v68, v69, v20
    v_max3_f32 v21, v70, v71, v21
    v_max3_f32 v20, v72, v73, v20
    v_max3_f32 v21, v74, v75, v21
    v_max3_f32 v20, v76, v77, v20
    v_max3_f32 v21, v78, v79, v21
    v_max3_f32 v20, v80, v81, v20
    v_max3_f32 v21, v82, v83, v21
    s_nop 1
RSK_58:
    s_cmp_gt_u32 s75, 6
    s_cbranch_scc1 RSK_59
    ds_read_b128 v[36:39], v2 offset:6144
    s_waitcnt lgkmcnt(0)
    v_mfma_f32_32x32x16_bf16 v[68:83], v[36:39], v[32:35], 0
    s_nop 11
    v_max3_f32 v20, v68, v69, v20
    v_max3_f32 v21, v70, v71, v21
    v_max3_f32 v20, v72, v73, v20
    v_max3_f32 v21, v74, v75, v21
    v_max3_f32 v20, v76, v77, v20
    v_max3_f32 v21, v78, v79, v21
    v_max3_f32 v20, v80, v81, v20
    v_max3_f32 v21, v82, v83, v21
    s_nop 1
RSK_59:
    s_cmp_gt_u32 s75, 7
    s_cbranch_scc1 RSK_60
    ds_read_b128 v[36:39], v2 offset:7168
    s_waitcnt lgkmcnt(0)
    v_mfma_f32_32x32x16_bf16 v[68:83], v[36:39], v[32:35], 0
    s_nop 11
    v_max3_f32 v20, v68, v69, v20
    v_max3_f32 v21, v70, v71, v21
    v_max3_f32 v20, v72, v73, v20
    v_max3_f32 v21, v74, v75, v21
    v_max3_f32 v20, v76, v77, v20
    v_max3_f32 v21, v78, v79, v21
    v_max3_f32 v20, v80, v81, v20
    v_max3_f32 v21, v82, v83, v21
    s_nop 1
RSK_60:
    ds_read_b128 v[36:39], v2 offset:8192
    v_sub_f32 v68, v30, v116
    v_sub_f32 v69, v30, v117
    v_sub_f32 v70, v30, v118
    v_sub_f32 v71, v30, v119
    v_sub_f32 v72, v30, v120
    v_sub_f32 v73, v30, v121
    v_sub_f32 v74, v30, v122
    v_sub_f32 v75, v30, v123
    v_sub_f32 v76, v30, v124
    v_sub_f32 v77, v30, v125
    v_sub_f32 v78, v30, v126
    v_sub_f32 v79, v30, v127
    v_sub_f32 v80, v30, v128
    v_sub_f32 v81, v30, v129
    v_sub_f32 v82, v30, v130
    v_sub_f32 v83, v30, v131
    s_waitcnt lgkmcnt(0)
    s_nop 0
    v_mfma_f32_32x32x16_bf16 v[68:83], v[36:39], v[32:35], v[68:83]
    s_nop 11
    v_max3_f32 v20, v68, v69, v20
    v_max3_f32 v21, v70, v71, v21
    v_max3_f32 v20, v72, v73, v20
    v_max3_f32 v21, v74, v75, v21
    v_max3_f32 v20, v76, v77, v20
    v_max3_f32 v21, v78, v79, v21
    v_max3_f32 v20, v80, v81, v20
    v_max3_f32 v21, v82, v83, v21
    s_nop 1
RSK_61:
    ds_read_b128 v[40:43], v2 offset:7168
    s_mov_b64 exec, s[90:91]
    ds_read_b128 v[44:47], v3 offset:24576
    ds_read_b128 v[48:51], v3 offset:25088
    s_mov_b64 exec, -1
    v_mov_b32 v30, 1
    s_waitcnt lgkmcnt(0)
    s_nop 1
    s_branch PASS2_32
SMOK_52:
    v_rcp_f32 v20, v140
    s_nop 0
    v_mul_f32 v132, v20, v132
    v_mul_f32 v133, v20, v133
    v_mul_f32 v134, v20, v134
    v_mul_f32 v135, v20, v135
    v_mul_f32 v136, v20, v136
    v_mul_f32 v137, v20, v137
    v_mul_f32 v138, v20, v138
    v_mul_f32 v139, v20, v139
    v_cvt_pk_bf16_f32 v60, v132, v133
    v_cvt_pk_bf16_f32 v61, v134, v135
    v_cvt_pk_bf16_f32 v62, v136, v137
    v_cvt_pk_bf16_f32 v63, v138, v139
    buffer_store_dwordx4 v[60:63], v15, s[28:31], s74 offen sc1
    s_waitcnt vmcnt(20)
    v_mfma_f32_32x32x16_bf16 v[80:95], v[192:195], v[148:151], 0
    buffer_load_dwordx4 v[112:115], v15, s[28:31], s62 offen offset:3072 sc1
    v_mfma_f32_32x32x16_bf16 v[96:111], v[196:199], v[148:151], 0
    s_and_b32 s60, s73, 7
    s_add_u32 s60, s60, 1
    s_lshl_b32 s60, s60, 2
    s_lshr_b64 s[60:61], s[40:41], s60
    s_and_b32 s60, s60, 15
    s_lshl_b32 s62, s60, 14
    s_add_u32 s62, s62, s71
    buffer_load_dwordx4 v[116:119], v15, s[28:31], s62 offen offset:0 sc1
    s_waitcnt vmcnt(21)
    v_mfma_f32_32x32x16_bf16 v[80:95], v[200:203], v[152:155], v[80:95]
    buffer_load_dwordx4 v[120:123], v15, s[28:31], s62 offen offset:1024 sc1
    v_mfma_f32_32x32x16_bf16 v[96:111], v[204:207], v[152:155], v[96:111]
    buffer_load_dwordx4 v[124:127], v15, s[28:31], s62 offen offset:2048 sc1
    s_waitcnt vmcnt(22)
    v_mfma_f32_32x32x16_bf16 v[80:95], v[208:211], v[156:159], v[80:95]
    buffer_load_dwordx4 v[128:131], v15, s[28:31], s62 offen offset:3072 sc1
    v_mfma_f32_32x32x16_bf16 v[96:111], v[212:215], v[156:159], v[96:111]
    s_and_b32 s60, s73, 7
    s_add_u32 s60, s60, 2
    s_lshl_b32 s60, s60, 2
    s_lshr_b64 s[60:61], s[40:41], s60
    s_and_b32 s60, s60, 15
    s_lshl_b32 s62, s60, 14
    s_add_u32 s62, s62, s71
    buffer_load_dwordx4 v[132:135], v15, s[28:31], s62 offen offset:0 sc1
    s_waitcnt vmcnt(23)
    v_mfma_f32_32x32x16_bf16 v[80:95], v[216:219], v[160:163], v[80:95]
    buffer_load_dwordx4 v[136:139], v15, s[28:31], s62 offen offset:1024 sc1
    v_mfma_f32_32x32x16_bf16 v[96:111], v[220:223], v[160:163], v[96:111]
    buffer_load_dwordx4 v[140:143], v15, s[28:31], s62 offen offset:2048 sc1
    s_waitcnt vmcnt(20)
    v_mfma_f32_32x32x16_bf16 v[80:95], v[224:227], v[164:167], v[80:95]
    buffer_load_dwordx4 v[144:147], v15, s[28:31], s62 offen offset:3072 sc1
    v_mfma_f32_32x32x16_bf16 v[96:111], v[228:231], v[164:167], v[96:111]
    s_waitcnt vmcnt(20)
    v_mfma_f32_32x32x16_bf16 v[80:95], v[232:235], v[168:171], v[80:95]
    v_mfma_f32_32x32x16_bf16 v[96:111], v[236:239], v[168:171], v[96:111]
    s_waitcnt vmcnt(19)
    v_mfma_f32_32x32x16_bf16 v[80:95], v[240:243], v[172:175], v[80:95]
    v_mfma_f32_32x32x16_bf16 v[96:111], v[244:247], v[172:175], v[96:111]
    s_waitcnt vmcnt(18)
    v_mfma_f32_32x32x16_bf16 v[80:95], v[248:251], v[176:179], v[80:95]
    v_mfma_f32_32x32x16_bf16 v[96:111], v[252:255], v[176:179], v[96:111]
    v_lshrrev_b32 v35, 3, v0
    v_and_b32 v36, 7, v0
    s_lshl3_add_u32 s87, s95, s48
    s_lshl_b32 s87, s87, 3
    v_add_u32 v37, s87, v35
    s_lshl_b32 s88, s96, 7
    v_lshl_add_u32 v38, v36, 4, s88
    v_lshl_add_u32 v8, v37, 10, v38
    s_waitcnt vmcnt(9)
    s_waitcnt lgkmcnt(0)
    s_barrier
    s_nop 0
    s_cmp_lg_u32 s48, 0
    s_cbranch_scc1 W0_62
    buffer_store_dword v25, v5, s[28:31], s77 offen offset:0 sc1
W0_62:
    ds_read_b64_tr_b16 v[48:49], v12 offset:0
    ds_read_b64_tr_b16 v[50:51], v12 offset:4096
    ds_read_b64_tr_b16 v[52:53], v13 offset:0
    ds_read_b64_tr_b16 v[54:55], v13 offset:4096
    ds_read_b64_tr_b16 v[56:57], v12 offset:8192
    ds_read_b64_tr_b16 v[58:59], v12 offset:12288
    ds_read_b64_tr_b16 v[60:61], v13 offset:8192
    ds_read_b64_tr_b16 v[62:63], v13 offset:12288
    ds_read_b64_tr_b16 v[64:65], v12 offset:16384
    ds_read_b64_tr_b16 v[66:67], v12 offset:20480
    ds_read_b64_tr_b16 v[68:69], v13 offset:16384
    ds_read_b64_tr_b16 v[70:71], v13 offset:20480
    s_waitcnt lgkmcnt(10)
    v_mfma_f32_32x32x16_bf16 v[80:95], v[48:51], v[180:183], v[80:95]
    s_and_b32 s60, s73, 7
    s_add_u32 s60, s60, 4
    s_lshl_b32 s60, s60, 2
    s_lshr_b64 s[60:61], s[40:41], s60
    s_and_b32 s60, s60, 15
    s_add_u32 m0, s55, 131072
    s_lshl_b32 s100, s60, 18
    buffer_load_dwordx4 v1, s[20:23], s100 offen offset:0 lds
    s_waitcnt lgkmcnt(8)
    v_mfma_f32_32x32x16_bf16 v[96:111], v[52:55], v[180:183], v[96:111]
    s_add_u32 s100, s100, 64512
    buffer_load_dwordx4 v1, s[20:23], s100 offen offset:1024 lds
    ds_read_b64_tr_b16 v[72:73], v12 offset:24576
    ds_read_b64_tr_b16 v[74:75], v12 offset:28672
    ds_read_b64_tr_b16 v[76:77], v13 offset:24576
    ds_read_b64_tr_b16 v[78:79], v13 offset:28672
    s_waitcnt lgkmcnt(10)
    v_mfma_f32_32x32x16_bf16 v[80:95], v[56:59], v[184:187], v[80:95]
    s_add_u32 s100, s100, 64512
    buffer_load_dwordx4 v1, s[20:23], s100 offen offset:2048 lds
    s_waitcnt lgkmcnt(8)
    v_mfma_f32_32x32x16_bf16 v[96:111], v[60:63], v[184:187], v[96:111]
    s_add_u32 s100, s100, 64512
    buffer_load_dwordx4 v1, s[20:23], s100 offen offset:3072 lds
    ds_read_b64_tr_b16 v[48:49], v6 offset:32768
    ds_read_b64_tr_b16 v[50:51], v6 offset:36864
    ds_read_b64_tr_b16 v[52:53], v7 offset:32768
    ds_read_b64_tr_b16 v[54:55], v7 offset:36864
    s_waitcnt lgkmcnt(10)
    v_mfma_f32_32x32x16_bf16 v[80:95], v[64:67], v[188:191], v[80:95]
    s_and_b32 s60, s73, 7
    s_add_u32 s60, s60, 3
    s_lshl_b32 s60, s60, 2
    s_lshr_b64 s[60:61], s[40:41], s60
    s_and_b32 s60, s60, 15
    s_lshl_b32 s62, s60, 14
    s_add_u32 s62, s62, s71
    buffer_load_dwordx4 v[192:195], v15, s[28:31], s62 offen offset:0 sc1
    s_waitcnt lgkmcnt(8)
    v_mfma_f32_32x32x16_bf16 v[96:111], v[68:71], v[188:191], v[96:111]
    buffer_load_dwordx4 v[196:199], v15, s[28:31], s62 offen offset:1024 sc1
    s_waitcnt lgkmcnt(0)
    s_barrier
    ds_read_b64_tr_b16 v[56:57], v6 offset:40960
    ds_read_b64_tr_b16 v[58:59], v6 offset:45056
    ds_read_b64_tr_b16 v[60:61], v7 offset:40960
    ds_read_b64_tr_b16 v[62:63], v7 offset:45056
    s_waitcnt vmcnt(14)
    v_mfma_f32_32x32x16_bf16 v[80:95], v[72:75], v[112:115], v[80:95]
    buffer_load_dwordx4 v[200:203], v15, s[28:31], s62 offen offset:2048 sc1
    v_mfma_f32_32x32x16_bf16 v[96:111], v[76:79], v[112:115], v[96:111]
    buffer_load_dwordx4 v[204:207], v15, s[28:31], s62 offen offset:3072 sc1
    ds_read_b64_tr_b16 v[64:65], v6 offset:49152
    ds_read_b64_tr_b16 v[66:67], v6 offset:53248
    ds_read_b64_tr_b16 v[68:69], v7 offset:49152
    ds_read_b64_tr_b16 v[70:71], v7 offset:53248
    s_waitcnt vmcnt(15)
    v_mfma_f32_32x32x16_bf16 v[80:95], v[48:51], v[116:119], v[80:95]
    s_and_b32 s60, s73, 7
    s_add_u32 s60, s60, 4
    s_lshl_b32 s60, s60, 2
    s_lshr_b64 s[60:61], s[40:41], s60
    s_and_b32 s60, s60, 15
    s_lshl_b32 s62, s60, 14
    s_add_u32 s62, s62, s71
    buffer_load_dwordx4 v[208:211], v15, s[28:31], s62 offen offset:0 sc1
    v_mfma_f32_32x32x16_bf16 v[96:111], v[52:55], v[116:119], v[96:111]
    buffer_load_dwordx4 v[212:215], v15, s[28:31], s62 offen offset:1024 sc1
    ds_read_b64_tr_b16 v[72:73], v6 offset:57344
    ds_read_b64_tr_b16 v[74:75], v6 offset:61440
    ds_read_b64_tr_b16 v[76:77], v7 offset:57344
    ds_read_b64_tr_b16 v[78:79], v7 offset:61440
    s_waitcnt vmcnt(16) lgkmcnt(10)
    v_mfma_f32_32x32x16_bf16 v[80:95], v[56:59], v[120:123], v[80:95]
    buffer_load_dwordx4 v[216:219], v15, s[28:31], s62 offen offset:2048 sc1
    s_waitcnt lgkmcnt(8)
    v_mfma_f32_32x32x16_bf16 v[96:111], v[60:63], v[120:123], v[96:111]
    buffer_load_dwordx4 v[220:223], v15, s[28:31], s62 offen offset:3072 sc1
    ds_read_b64_tr_b16 v[48:49], v12 offset:32768
    ds_read_b64_tr_b16 v[50:51], v12 offset:36864
    ds_read_b64_tr_b16 v[52:53], v13 offset:32768
    ds_read_b64_tr_b16 v[54:55], v13 offset:36864
    s_waitcnt vmcnt(17) lgkmcnt(10)
    v_mfma_f32_32x32x16_bf16 v[80:95], v[64:67], v[124:127], v[80:95]
    s_bfe_u32 s60, s73, 0x10003
    s_xor_b32 s60, s60, 0
    s_add_u32 m0, s55, 65536
    s_lshl_b32 s100, s60, 18
    buffer_load_dwordx4 v1, s[24:27], s100 offen offset:0 lds
    s_waitcnt lgkmcnt(8)
    v_mfma_f32_32x32x16_bf16 v[96:111], v[68:71], v[124:127], v[96:111]
    s_add_u32 s100, s100, 64512
    buffer_load_dwordx4 v1, s[24:27], s100 offen offset:1024 lds
    s_waitcnt lgkmcnt(0)
    s_barrier
    ds_read_b64_tr_b16 v[56:57], v12 offset:40960
    ds_read_b64_tr_b16 v[58:59], v12 offset:45056
    ds_read_b64_tr_b16 v[60:61], v13 offset:40960
    ds_read_b64_tr_b16 v[62:63], v13 offset:45056
    s_waitcnt vmcnt(18)
    v_mfma_f32_32x32x16_bf16 v[80:95], v[72:75], v[128:131], v[80:95]
    s_add_u32 s100, s100, 64512
    buffer_load_dwordx4 v1, s[24:27], s100 offen offset:2048 lds
    v_mfma_f32_32x32x16_bf16 v[96:111], v[76:79], v[128:131], v[96:111]
    s_add_u32 s100, s100, 64512
    buffer_load_dwordx4 v1, s[24:27], s100 offen offset:3072 lds
    ds_read_b64_tr_b16 v[64:65], v12 offset:49152
    ds_read_b64_tr_b16 v[66:67], v12 offset:53248
    ds_read_b64_tr_b16 v[68:69], v13 offset:49152
    ds_read_b64_tr_b16 v[70:71], v13 offset:53248
    s_waitcnt vmcnt(19)
    v_mfma_f32_32x32x16_bf16 v[80:95], v[48:51], v[132:135], v[80:95]
    s_bfe_u32 s60, s73, 0x10003
    s_xor_b32 s60, s60, 1
    s_add_u32 m0, s55, 32768
    s_lshl_b32 s100, s60, 18
    buffer_load_dwordx4 v1, s[24:27], s100 offen offset:0 lds
    v_mfma_f32_32x32x16_bf16 v[96:111], v[52:55], v[132:135], v[96:111]
    s_add_u32 s100, s100, 64512
    buffer_load_dwordx4 v1, s[24:27], s100 offen offset:1024 lds
    ds_read_b64_tr_b16 v[72:73], v12 offset:57344
    ds_read_b64_tr_b16 v[74:75], v12 offset:61440
    ds_read_b64_tr_b16 v[76:77], v13 offset:57344
    ds_read_b64_tr_b16 v[78:79], v13 offset:61440
    s_waitcnt vmcnt(20) lgkmcnt(10)
    v_mfma_f32_32x32x16_bf16 v[80:95], v[56:59], v[136:139], v[80:95]
    s_add_u32 s100, s100, 64512
    buffer_load_dwordx4 v1, s[24:27], s100 offen offset:2048 lds
    s_waitcnt lgkmcnt(8)
    v_mfma_f32_32x32x16_bf16 v[96:111], v[60:63], v[136:139], v[96:111]
    s_add_u32 s100, s100, 64512
    buffer_load_dwordx4 v1, s[24:27], s100 offen offset:3072 lds
    buffer_load_dword v30, v28, s[28:31], 0 offen offset:1280 sc1
    ds_read_b64_tr_b16 v[48:49], v6 offset:0
    ds_read_b64_tr_b16 v[50:51], v6 offset:4096
    ds_read_b64_tr_b16 v[52:53], v7 offset:0
    ds_read_b64_tr_b16 v[54:55], v7 offset:4096
    s_waitcnt vmcnt(22) lgkmcnt(10)
    v_mfma_f32_32x32x16_bf16 v[80:95], v[64:67], v[140:143], v[80:95]
    s_waitcnt lgkmcnt(8)
    v_mfma_f32_32x32x16_bf16 v[96:111], v[68:71], v[140:143], v[96:111]
    ds_read_b64_tr_b16 v[56:57], v6 offset:8192
    ds_read_b64_tr_b16 v[58:59], v6 offset:12288
    ds_read_b64_tr_b16 v[60:61], v7 offset:8192
    ds_read_b64_tr_b16 v[62:63], v7 offset:12288
    s_waitcnt vmcnt(21) lgkmcnt(10)
    v_mfma_f32_32x32x16_bf16 v[80:95], v[72:75], v[144:147], v[80:95]
    s_waitcnt lgkmcnt(8)
    v_mfma_f32_32x32x16_bf16 v[96:111], v[76:79], v[144:147], v[96:111]
    ds_read_b64_tr_b16 v[64:65], v6 offset:16384
    ds_read_b64_tr_b16 v[66:67], v6 offset:20480
    ds_read_b64_tr_b16 v[68:69], v7 offset:16384
    ds_read_b64_tr_b16 v[70:71], v7 offset:20480
    s_waitcnt vmcnt(16) lgkmcnt(10)
    v_mfma_f32_32x32x16_bf16 v[80:95], v[48:51], v[192:195], v[80:95]
    s_waitcnt lgkmcnt(8)
    v_mfma_f32_32x32x16_bf16 v[96:111], v[52:55], v[192:195], v[96:111]
    ds_read_b64_tr_b16 v[72:73], v6 offset:24576
    ds_read_b64_tr_b16 v[74:75], v6 offset:28672
    ds_read_b64_tr_b16 v[76:77], v7 offset:24576
    ds_read_b64_tr_b16 v[78:79], v7 offset:28672
    s_waitcnt vmcnt(15) lgkmcnt(10)
    v_mfma_f32_32x32x16_bf16 v[80:95], v[56:59], v[196:199], v[80:95]
    s_waitcnt lgkmcnt(8)
    v_mfma_f32_32x32x16_bf16 v[96:111], v[60:63], v[196:199], v[96:111]
    s_nop 11
    s_cmp_lg_u32 s48, 0
    s_cbranch_scc1 W0_63
    s_mov_b32 s68, -1
    s_waitcnt vmcnt(0)
    v_cmp_ne_u32 vcc, 1, v30
    s_nop 0
    s_andn2_b64 vcc, s[68:69], vcc
    s_cmp_eq_u64 vcc, s[68:69]
    s_cbranch_scc1 OCOK_64
    s_mov_b32 s94, 0
OCLP_65:
    s_sleep 2
    buffer_load_dword v30, v28, s[28:31], 0 offen offset:1280 sc1
    s_waitcnt vmcnt(0)
    s_add_u32 s94, s94, 1
    s_cmp_gt_u32 s94, 0x40000
    s_cbranch_scc1 OCOK_64
    v_cmp_ne_u32 vcc, 1, v30
    s_nop 0
    s_andn2_b64 vcc, s[68:69], vcc
    s_cmp_eq_u64 vcc, s[68:69]
    s_cbranch_scc0 OCLP_65
OCOK_64:
W0_63:
    s_waitcnt lgkmcnt(0)
    s_barrier
    ds_read_b64_tr_b16 v[48:49], v22 offset:0
    ds_read_b64_tr_b16 v[50:51], v22 offset:4096
    ds_read_b64_tr_b16 v[52:53], v23 offset:0
    ds_read_b64_tr_b16 v[54:55], v23 offset:4096
    s_waitcnt vmcnt(14)
    v_mfma_f32_32x32x16_bf16 v[80:95], v[64:67], v[200:203], v[80:95]
    s_bfe_u32 s60, s73, 0x10003
    s_xor_b32 s60, s60, 0
    s_add_u32 s60, s60, 7
    s_lshl_b32 s62, s60, 14
    s_add_u32 s62, s62, s71
    buffer_load_dwordx4 v[224:227], v15, s[28:31], s62 offen offset:0 sc1
    v_mfma_f32_32x32x16_bf16 v[96:111], v[68:71], v[200:203], v[96:111]
    buffer_load_dwordx4 v[228:231], v15, s[28:31], s62 offen offset:1024 sc1
    ds_read_b64_tr_b16 v[56:57], v22 offset:8192
    ds_read_b64_tr_b16 v[58:59], v22 offset:12288
    ds_read_b64_tr_b16 v[60:61], v23 offset:8192
    ds_read_b64_tr_b16 v[62:63], v23 offset:12288
    s_waitcnt vmcnt(15)
    v_mfma_f32_32x32x16_bf16 v[80:95], v[72:75], v[204:207], v[80:95]
    buffer_load_dwordx4 v[232:235], v15, s[28:31], s62 offen offset:2048 sc1
    v_mfma_f32_32x32x16_bf16 v[96:111], v[76:79], v[204:207], v[96:111]
    buffer_load_dwordx4 v[236:239], v15, s[28:31], s62 offen offset:3072 sc1
    ds_read_b64_tr_b16 v[64:65], v22 offset:16384
    ds_read_b64_tr_b16 v[66:67], v22 offset:20480
    ds_read_b64_tr_b16 v[68:69], v23 offset:16384
    ds_read_b64_tr_b16 v[70:71], v23 offset:20480
    s_waitcnt vmcnt(16) lgkmcnt(10)
    v_mfma_f32_32x32x16_bf16 v[80:95], v[48:51], v[208:211], v[80:95]
    s_bfe_u32 s60, s73, 0x10003
    s_xor_b32 s60, s60, 1
    s_add_u32 s60, s60, 7
    s_lshl_b32 s62, s60, 14
    s_add_u32 s62, s62, s71
    buffer_load_dwordx4 v[240:243], v15, s[28:31], s62 offen offset:0 sc1
    s_waitcnt lgkmcnt(8)
    v_mfma_f32_32x32x16_bf16 v[96:111], v[52:55], v[208:211], v[96:111]
    buffer_load_dwordx4 v[244:247], v15, s[28:31], s62 offen offset:1024 sc1
    ds_read_b64_tr_b16 v[72:73], v22 offset:24576
    ds_read_b64_tr_b16 v[74:75], v22 offset:28672
    ds_read_b64_tr_b16 v[76:77], v23 offset:24576
    ds_read_b64_tr_b16 v[78:79], v23 offset:28672
    s_waitcnt vmcnt(17) lgkmcnt(10)
    v_mfma_f32_32x32x16_bf16 v[80:95], v[56:59], v[212:215], v[80:95]
    buffer_load_dwordx4 v[248:251], v15, s[28:31], s62 offen offset:2048 sc1
    s_waitcnt lgkmcnt(8)
    v_mfma_f32_32x32x16_bf16 v[96:111], v[60:63], v[212:215], v[96:111]
    buffer_load_dwordx4 v[252:255], v15, s[28:31], s62 offen offset:3072 sc1
    s_waitcnt vmcnt(9)
    s_waitcnt lgkmcnt(0)
    s_barrier
    ds_read_b64_tr_b16 v[48:49], v12 offset:0
    ds_read_b64_tr_b16 v[50:51], v12 offset:4096
    ds_read_b64_tr_b16 v[52:53], v13 offset:0
    ds_read_b64_tr_b16 v[54:55], v13 offset:4096
    v_mfma_f32_32x32x16_bf16 v[80:95], v[64:67], v[216:219], v[80:95]
    v_mfma_f32_32x32x16_bf16 v[96:111], v[68:71], v[216:219], v[96:111]
    ds_read_b64_tr_b16 v[56:57], v12 offset:8192
    ds_read_b64_tr_b16 v[58:59], v12 offset:12288
    ds_read_b64_tr_b16 v[60:61], v13 offset:8192
    ds_read_b64_tr_b16 v[62:63], v13 offset:12288
    v_mfma_f32_32x32x16_bf16 v[80:95], v[72:75], v[220:223], v[80:95]
    buffer_load_dwordx4 v[40:43], v8, s[8:11], 0 offen
    buffer_load_dwordx4 v[44:47], v38, s[44:47], 0 offen
    v_mfma_f32_32x32x16_bf16 v[96:111], v[76:79], v[220:223], v[96:111]
    ds_read_b64_tr_b16 v[64:65], v12 offset:16384
    ds_read_b64_tr_b16 v[66:67], v12 offset:20480
    ds_read_b64_tr_b16 v[68:69], v13 offset:16384
    ds_read_b64_tr_b16 v[70:71], v13 offset:20480
    s_waitcnt vmcnt(9) lgkmcnt(10)
    v_mfma_f32_32x32x16_bf16 v[80:95], v[48:51], v[224:227], v[80:95]
    s_waitcnt lgkmcnt(8)
    v_mfma_f32_32x32x16_bf16 v[96:111], v[52:55], v[224:227], v[96:111]
    ds_read_b64_tr_b16 v[72:73], v12 offset:24576
    ds_read_b64_tr_b16 v[74:75], v12 offset:28672
    ds_read_b64_tr_b16 v[76:77], v13 offset:24576
    ds_read_b64_tr_b16 v[78:79], v13 offset:28672
    s_waitcnt vmcnt(8) lgkmcnt(10)
    v_mfma_f32_32x32x16_bf16 v[80:95], v[56:59], v[228:231], v[80:95]
    s_waitcnt lgkmcnt(8)
    v_mfma_f32_32x32x16_bf16 v[96:111], v[60:63], v[228:231], v[96:111]
    ds_read_b64_tr_b16 v[48:49], v6 offset:32768
    ds_read_b64_tr_b16 v[50:51], v6 offset:36864
    ds_read_b64_tr_b16 v[52:53], v7 offset:32768
    ds_read_b64_tr_b16 v[54:55], v7 offset:36864
    s_waitcnt vmcnt(7) lgkmcnt(10)
    v_mfma_f32_32x32x16_bf16 v[80:95], v[64:67], v[232:235], v[80:95]
    s_waitcnt lgkmcnt(8)
    v_mfma_f32_32x32x16_bf16 v[96:111], v[68:71], v[232:235], v[96:111]
    ds_read_b64_tr_b16 v[56:57], v6 offset:40960
    ds_read_b64_tr_b16 v[58:59], v6 offset:45056
    ds_read_b64_tr_b16 v[60:61], v7 offset:40960
    ds_read_b64_tr_b16 v[62:63], v7 offset:45056
    s_waitcnt vmcnt(6) lgkmcnt(10)
    v_mfma_f32_32x32x16_bf16 v[80:95], v[72:75], v[236:239], v[80:95]
    s_waitcnt lgkmcnt(8)
    v_mfma_f32_32x32x16_bf16 v[96:111], v[76:79], v[236:239], v[96:111]
    ds_read_b64_tr_b16 v[64:65], v6 offset:49152
    ds_read_b64_tr_b16 v[66:67], v6 offset:53248
    ds_read_b64_tr_b16 v[68:69], v7 offset:49152
    ds_read_b64_tr_b16 v[70:71], v7 offset:53248
    s_waitcnt vmcnt(5) lgkmcnt(10)
    v_mfma_f32_32x32x16_bf16 v[80:95], v[48:51], v[240:243], v[80:95]
    s_waitcnt lgkmcnt(8)
    v_mfma_f32_32x32x16_bf16 v[96:111], v[52:55], v[240:243], v[96:111]
    ds_read_b64_tr_b16 v[72:73], v6 offset:57344
    ds_read_b64_tr_b16 v[74:75], v6 offset:61440
    ds_read_b64_tr_b16 v[76:77], v7 offset:57344
    ds_read_b64_tr_b16 v[78:79], v7 offset:61440
    s_waitcnt vmcnt(4) lgkmcnt(10)
    v_mfma_f32_32x32x16_bf16 v[80:95], v[56:59], v[244:247], v[80:95]
    s_waitcnt lgkmcnt(8)
    v_mfma_f32_32x32x16_bf16 v[96:111], v[60:63], v[244:247], v[96:111]
    s_waitcnt vmcnt(3) lgkmcnt(6)
    v_mfma_f32_32x32x16_bf16 v[80:95], v[64:67], v[248:251], v[80:95]
    s_waitcnt lgkmcnt(4)
    v_mfma_f32_32x32x16_bf16 v[96:111], v[68:71], v[248:251], v[96:111]
    s_waitcnt vmcnt(2) lgkmcnt(2)
    v_mfma_f32_32x32x16_bf16 v[80:95], v[72:75], v[252:255], v[80:95]
    s_waitcnt lgkmcnt(0)
    v_mfma_f32_32x32x16_bf16 v[96:111], v[76:79], v[252:255], v[96:111]
    s_lshl1_add_u32 s88, s76, s49
    s_lshl_b32 s88, s88, 13
    s_lshr_b32 s87, s76, 1
    s_lshl_b32 s87, s87, 16
    s_add_u32 s88, s88, s87
    v_add_u32 v9, s88, v15
    v_xor_b32 v10, 0, v9
    s_nop 2
    ds_write_b128 v10, v[80:83] offset:0
    v_xor_b32 v10, 32, v9
    ds_write_b128 v10, v[84:87] offset:1024
    v_xor_b32 v10, 64, v9
    ds_write_b128 v10, v[88:91] offset:2048
    v_xor_b32 v10, 96, v9
    ds_write_b128 v10, v[92:95] offset:3072
    v_xor_b32 v10, 128, v9
    ds_write_b128 v10, v[96:99] offset:4096
    v_xor_b32 v10, 160, v9
    ds_write_b128 v10, v[100:103] offset:5120
    v_xor_b32 v10, 192, v9
    ds_write_b128 v10, v[104:107] offset:6144
    v_xor_b32 v10, 224, v9
    ds_write_b128 v10, v[108:111] offset:7168
    s_lshl_b32 s88, s76, 7
    s_lshl_b32 s87, s49, 13
    s_add_u32 s88, s88, s87
    v_lshl_add_u32 v9, v35, 4, s88
    v_lshlrev_b32 v10, 5, v36
    v_xor_b32 v9, v9, v10
    v_lshl_add_u32 v9, v36, 10, v9
    v_add_u32 v10, 0x10000, v9
    s_waitcnt vmcnt(1)
    v_lshlrev_b32 v112, 16, v40
    v_and_b32 v113, 0xffff0000, v40
    s_waitcnt vmcnt(0)
    v_lshlrev_b32 v120, 16, v44
    v_and_b32 v121, 0xffff0000, v44
    v_lshlrev_b32 v114, 16, v41
    v_and_b32 v115, 0xffff0000, v41
    v_lshlrev_b32 v122, 16, v45
    v_and_b32 v123, 0xffff0000, v45
    v_lshlrev_b32 v116, 16, v42
    v_and_b32 v117, 0xffff0000, v42
    v_lshlrev_b32 v124, 16, v46
    v_and_b32 v125, 0xffff0000, v46
    v_lshlrev_b32 v118, 16, v43
    v_and_b32 v119, 0xffff0000, v43
    v_lshlrev_b32 v126, 16, v47
    v_and_b32 v127, 0xffff0000, v47
    v_add_f32 v112, v112, v120
    v_add_f32 v113, v113, v121
    v_add_f32 v114, v114, v122
    v_add_f32 v115, v115, v123
    v_add_f32 v116, v116, v124
    v_add_f32 v117, v117, v125
    v_add_f32 v118, v118, v126
    v_add_f32 v119, v119, v127
    s_waitcnt lgkmcnt(0)
    s_barrier
    ds_read_b128 v[48:51], v9 offset:0
    ds_read_b128 v[52:55], v9 offset:512
    ds_read_b128 v[56:59], v9 offset:16384
    ds_read_b128 v[60:63], v9 offset:16896
    ds_read_b128 v[64:67], v10 offset:32768
    ds_read_b128 v[68:71], v10 offset:33280
    ds_read_b128 v[72:75], v10 offset:49152
    ds_read_b128 v[76:79], v10 offset:49664
    s_waitcnt lgkmcnt(7)
    v_add_f32 v112, v112, v48
    v_add_f32 v113, v113, v49
    v_add_f32 v114, v114, v50
    v_add_f32 v115, v115, v51
    s_waitcnt lgkmcnt(6)
    v_add_f32 v116, v116, v52
    v_add_f32 v117, v117, v53
    v_add_f32 v118, v118, v54
    v_add_f32 v119, v119, v55
    s_waitcnt lgkmcnt(3)
    v_add_f32 v56, v56, v64
    v_add_f32 v57, v57, v65
    v_add_f32 v58, v58, v66
    v_add_f32 v59, v59, v67
    s_waitcnt lgkmcnt(2)
    v_add_f32 v60, v60, v68
    v_add_f32 v61, v61, v69
    v_add_f32 v62, v62, v70
    v_add_f32 v63, v63, v71
    s_waitcnt lgkmcnt(1)
    v_add_f32 v112, v112, v72
    v_add_f32 v113, v113, v73
    v_add_f32 v114, v114, v74
    v_add_f32 v115, v115, v75
    s_waitcnt lgkmcnt(0)
    v_add_f32 v116, v116, v76
    v_add_f32 v117, v117, v77
    v_add_f32 v118, v118, v78
    v_add_f32 v119, v119, v79
    v_add_f32 v112, v112, v56
    v_add_f32 v113, v113, v57
    v_add_f32 v114, v114, v58
    v_add_f32 v115, v115, v59
    v_add_f32 v116, v116, v60
    v_add_f32 v117, v117, v61
    v_add_f32 v118, v118, v62
    v_add_f32 v119, v119, v63
    v_cvt_pk_bf16_f32 v48, v112, v113
    v_cvt_pk_bf16_f32 v49, v114, v115
    v_cvt_pk_bf16_f32 v50, v116, v117
    v_cvt_pk_bf16_f32 v51, v118, v119
    buffer_store_dwordx4 v[48:51], v8, s[32:35], 0 offen
L_end:
    s_endpgm
.section .rodata,"a"
.p2align 6
.amdhsa_kernel parallel_sum__sliding_block__dense_activation_gelu__prompt_kernel
  .amdhsa_next_free_vgpr 256
  .amdhsa_next_free_sgpr 102
  .amdhsa_accum_offset 256
  .amdhsa_group_segment_fixed_size 0
  .amdhsa_kernarg_size 88
  .amdhsa_user_sgpr_count 2
  .amdhsa_user_sgpr_kernarg_segment_ptr 1
  .amdhsa_system_sgpr_workgroup_id_x 1
.end_amdhsa_kernel
```
